```python
import torch

def _softmax(x, axis=-1):
    return torch.softmax(x, dim=axis)
def _gelu(x):
    return torch.nn.functional.gelu(x, approximate="tanh")
def _silu(x):
    return torch.nn.functional.silu(x)
def _sigmoid(x):
    return torch.sigmoid(x)
def _layernorm(x, axis=-1, eps=1e-5):
    m = x.mean(dim=axis, keepdim=True)
    v = x.var(dim=axis, keepdim=True, unbiased=False)
    return (x - m) / torch.sqrt(v + eps)
def _scatter_add(tgt, idx, src, axis=0):
    return tgt.clone().index_add_(axis, idx, src)
def _segment_sum(src, seg, n):
    out = torch.zeros((n,) + src.shape[1:], dtype=src.dtype)
    return out.index_add_(0, seg, src)
def _pad(x, pw):
    flat = tuple(v for pair in reversed(pw) for v in pair)
    return torch.nn.functional.pad(x, flat)

kernel_name = 'sequential_preLN__ssm_conv_h3__dense_activation_relu__prompt'

def setup_inputs():

    _w = (lambda a: (lambda t: t.to(torch.bfloat16) if t.is_floating_point() else t)(torch.as_tensor(a)))
    def _A_setup():
        B, S, D = 1, 2048, 448
        ks = 4
        return {
            "q": _w((lambda *s: torch.randn(*s, dtype=torch.bfloat16) * 0.05)(B, S, D)),
            "k": _w((lambda *s: torch.randn(*s, dtype=torch.bfloat16) * 0.4)(B, S, D)),
            "v": _w((lambda *s: torch.randn(*s, dtype=torch.bfloat16) * 0.4)(B, S, D)),
            "shift_k": _w((lambda *s: torch.randn(*s, dtype=torch.bfloat16) * 0.4)(D, ks) * 0.5),
            "ssm_k": _w((lambda *s: torch.randn(*s, dtype=torch.bfloat16) * 0.4)(D, S) * (1.0 / S ** 0.5)),
            "ssm_D": _w((lambda *s: torch.randn(*s, dtype=torch.bfloat16) * 0.4)(D)),
        }
    _A_in = _A_setup()

    def _B_setup():
        B, S, D, Dff = 1, 2048, 448, 1792
        return {
            "x": _w((lambda *s: torch.randn(*s, dtype=torch.bfloat16) * 0.05)(B, S, D)),
            "w1": _w((lambda *s: torch.randn(*s, dtype=torch.bfloat16) * 0.05)(D, Dff)),
            "w2": _w((lambda *s: torch.randn(*s, dtype=torch.bfloat16) * 0.05)(Dff, D)),
        }
    _B_in = _B_setup()

    return {
        "A_q": _A_in["q"],
        "A_k": _A_in["k"],
        "A_v": _A_in["v"],
        "A_shift_k": _A_in["shift_k"],
        "A_ssm_k": _A_in["ssm_k"],
        "A_ssm_D": _A_in["ssm_D"],
        "B_x": _B_in["x"],
        "B_w1": _B_in["w1"],
        "B_w2": _B_in["w2"],
    }

def reference(A_q, A_k, A_v, A_shift_k, A_ssm_k, A_ssm_D, B_x, B_w1, B_w2):
    def _A_ref(q, k, v, shift_k, ssm_k, ssm_D):
        B, S, D = q.shape
        ks = shift_k.shape[-1]
        k_pad = _pad(k, ((0, 0), (ks - 1, 0), (0, 0)))
        k_shift = torch.zeros_like(k)
        for t in range(ks):
            k_shift = k_shift + k_pad[:, t:t + S, :] * shift_k[:, ks - 1 - t][None, None, :]
        kv = k_shift * v
        L = 2 * S
        kv_pad = _pad(kv, ((0, 0), (0, S), (0, 0)))
        kf_pad = _pad(ssm_k, ((0, 0), (0, S)))
        kv_f = (lambda x, axes=(-2,-1): torch.fft.rfft2(x.float(), dim=axes))(kv_pad[:, None, :, :], axes=(1, 2))
        kf_f = (lambda x, axes=(-2,-1): torch.fft.rfft2(x.float(), dim=axes))(kf_pad[:, None, :], axes=(1, 2))
        kf_f = (lambda x, *d: x.permute(*d))(kf_f, 1, 2, 0)
        y_f = kv_f * kf_f[None, :, :, :]
        y = (lambda x, s, axes=(-2,-1): torch.fft.irfft2(x, s=s, dim=axes).to(torch.bfloat16))(y_f, (1, L), axes=(1, 2))[:, 0, :S, :]
        y = y + kv * ssm_D[None, None, :]
        return q * y

    def _B_ref(x, w1, w2):
        h = torch.einsum("bsd,df->bsf", x, w1)
        zero = torch.zeros_like(h)
        h = torch.maximum(h, zero)
        return torch.einsum("bsf,fd->bsd", h, w2)

    x = A_q
    h = x + _A_ref(_layernorm(x, axis=-1), A_k, A_v, A_shift_k, A_ssm_k, A_ssm_D)
    h2 = h + _B_ref(_layernorm(h, axis=-1), B_w1, B_w2)
    return h2
```

```asm
; @launch grid=(256,1,1) block=(256,1,1) lds=132608
.amdgcn_target "amdgcn-amd-amdhsa--gfx950"
.text
.globl sequential_preLN__ssm_conv_h3__dense_activation_relu__prompt_kernel
.p2align 8
.type sequential_preLN__ssm_conv_h3__dense_activation_relu__prompt_kernel,@function
sequential_preLN__ssm_conv_h3__dense_activation_relu__prompt_kernel:
  s_cmp_ge_u32 s2, 256
  s_cbranch_scc1 KA_done
  s_load_dwordx4 s[4:7], s[0:1], 0
  s_load_dwordx4 s[8:11], s[0:1], 16
  s_load_dwordx4 s[12:15], s[0:1], 32
  s_load_dwordx4 s[16:19], s[0:1], 56
  s_load_dwordx4 s[20:23], s[0:1], 72
  s_load_dwordx2 s[24:25], s[0:1], 88
  v_lshrrev_b32 v1, 6, v0
  v_and_b32 v2, 63, v0
  v_readfirstlane_b32 s40, v1
  v_lshlrev_b32 v4, 4, v2
  s_cmp_lg_u32 s40, 3
  s_cbranch_scc1 KB_nocpf
  s_getpc_b64 s[26:27]
KB_pc:
  s_sub_u32 s26, s26, KB_pc-sequential_preLN__ssm_conv_h3__dense_activation_relu__prompt_kernel
  s_subb_u32 s27, s27, 0
  s_lshr_b32 s33, s2, 3
  s_lshl_b32 s33, s33, 10
  v_and_b32 v5, 7, v2
  v_lshlrev_b32 v5, 7, v5
  v_add_u32 v5, s33, v5
  v_min_u32 v5, KA_done-sequential_preLN__ssm_conv_h3__dense_activation_relu__prompt_kernel, v5
  global_load_dword v251, v5, s[26:27]
KB_nocpf:
  s_cmp_ge_u32 s2, 224
  s_cbranch_scc1 KA_aux
  s_and_b32 s41, s40, 1
  s_lshr_b32 s42, s40, 1
  s_lshl_b32 s43, s2, 1
  s_add_u32 s44, s43, s41
  s_lshl_b32 s45, s43, 12
  v_lshlrev_b32 v3, 4, v0
  s_and_b32 s50, s2, 7
  s_lshr_b32 s51, s2, 3
  s_mul_i32 s52, s51, 37
  s_lshr_b32 s52, s52, 8
  s_mul_i32 s53, s52, 7
  s_sub_u32 s59, s51, s53
  s_lshr_b32 s56, s50, 1
  s_lshl_b32 s56, s56, 2
  s_add_u32 s56, s56, s52
  s_and_b32 s57, s50, 1
  s_mul_i32 s57, s57, 7
  s_add_u32 s57, s57, s59
  s_lshl_b32 s58, s50, 2
  s_add_u32 s58, s58, s52
  s_mul_i32 s60, s2, 9363
  s_lshr_b32 s60, s60, 16
  s_mul_i32 s61, s60, 7
  s_sub_u32 s61, s2, s61
  s_mul_i32 s62, s60, 57344
  s_lshl_b32 s47, s61, 7
  s_add_u32 s62, s62, s47
  s_mul_i32 s64, s40, 7168
  s_add_u32 s64, s64, s62
  s_add_u32 s65, s64, 28672
  s_sub_u32 s66, s62, 7168
  v_lshrrev_b32 v8, 3, v2
  v_mul_u32_u24 v5, 896, v8
  v_bfe_u32 v6, v2, 1, 2
  v_bfe_u32 v7, v2, 4, 1
  v_xor_b32 v6, v6, v7
  s_lshl_b32 s47, s41, 1
  v_xor_b32 v6, s47, v6
  v_lshl_add_u32 v5, v6, 5, v5
  v_and_b32 v7, 1, v2
  v_lshl_add_u32 v5, v7, 4, v5
  v_xor_b32 v6, 64, v5
  s_lshl_b32 s48, s40, 10
  s_add_u32 s48, s48, 75264
  s_mov_b32 s54, 0xffff
  s_cmp_eq_u32 s40, 1
  s_cselect_b32 s54, s61, s54
  s_lshl_b32 s55, s40, 4
  s_or_b32 s55, s55, s61
  s_cmp_eq_u32 s55, 0x20
  s_cselect_b32 s54, 7, s54
  s_lshl_b32 s55, s60, 6
  s_lshl_b32 s67, s54, 3
  s_add_u32 s55, s55, s67
  v_add_u32 v61, s55, v8
  v_mul_u32_u24 v62, 896, v61
  v_and_b32 v63, 7, v2
  v_lshl_add_u32 v62, v63, 4, v62
  v_and_b32 v13, 15, v2
  s_lshl_b32 s67, s61, 6
  s_lshl_b32 s68, s40, 4
  s_add_u32 s67, s67, s68
  v_add_u32 v14, s67, v13
  v_lshlrev_b32 v15, 3, v14
  v_mov_b32 v9, s44
  v_lshlrev_b32 v9, 1, v9
  s_waitcnt lgkmcnt(0)
  s_mov_b32 s28, s24
  s_mov_b32 s29, s25
  s_mov_b32 s30, 20971520
  s_mov_b32 s31, 0x20000
  s_add_u32 s32, s12, s45
  s_addc_u32 s33, s13, 0
  s_mov_b32 s34, 4096
  s_mov_b32 s35, 0x20000
  s_add_u32 s36, s32, 4096
  s_addc_u32 s37, s33, 0
  s_mov_b32 s38, 4096
  s_mov_b32 s39, 0x20000
  buffer_load_dwordx4 v[200:203], v3, s[32:35], 0 offen offset:4 nt
  buffer_load_dwordx4 v[204:207], v3, s[32:35], 0 offen offset:8
  buffer_load_dword v208, v3, s[32:35], 0 offen
  buffer_load_dwordx4 v[212:215], v3, s[36:39], 0 offen offset:4 nt
  buffer_load_dwordx4 v[216:219], v3, s[36:39], 0 offen offset:8
  buffer_load_dword v220, v3, s[36:39], 0 offen
  s_mov_b32 s32, s6
  s_mov_b32 s33, s7
  s_mov_b32 s34, 1835008
  s_mov_b32 s35, 0x20000
  s_add_u32 m0, s48, 1024
  s_nop 0
  buffer_load_dwordx4 v6, s[32:35], s64 offen nt lds
  s_add_u32 m0, s48, 5120
  s_nop 0
  buffer_load_dwordx4 v6, s[32:35], s65 offen nt lds
  s_cmp_lg_u32 s40, 0
  s_cbranch_scc1 KA_nohalo
  s_cmp_eq_u32 s60, 0
  s_cbranch_scc1 KA_zerohalo
  s_mov_b32 m0, 75264
  s_nop 0
  buffer_load_dwordx4 v5, s[32:35], s66 offen lds
  s_branch KA_nohalo
KA_zerohalo:
  v_mov_b32 v16, 0
  v_mov_b32 v17, 0
  v_mov_b32 v18, 0
  v_mov_b32 v19, 0
  v_add_u32 v12, 75264, v4
  ds_write_b128 v12, v[16:19]
KA_nohalo:
  s_mov_b32 s36, s8
  s_mov_b32 s37, s9
  s_mov_b32 s38, 1835008
  s_mov_b32 s39, 0x20000
  s_add_u32 m0, s48, 9216
  s_nop 0
  buffer_load_dwordx4 v5, s[36:39], s64 offen nt lds
  s_add_u32 m0, s48, 13312
  s_nop 0
  buffer_load_dwordx4 v5, s[36:39], s65 offen nt lds
  s_mov_b32 s32, s4
  s_mov_b32 s33, s5
  s_mov_b32 s34, 1835008
  s_mov_b32 s35, 0x20000
  s_add_u32 m0, s48, 17408
  s_nop 0
  buffer_load_dwordx4 v5, s[32:35], s64 offen lds
  s_add_u32 m0, s48, 21504
  s_nop 0
  buffer_load_dwordx4 v5, s[32:35], s65 offen lds
  s_mov_b32 s36, s10
  s_mov_b32 s37, s11
  s_mov_b32 s38, 3584
  s_mov_b32 s39, 0x20000
  buffer_load_dwordx2 v[30:31], v15, s[36:39], 0 offen
  global_load_ushort v184, v9, s[14:15]
  s_cmp_eq_u32 s54, 0xffff
  s_cbranch_scc1 KA_nostl
  buffer_load_dwordx4 v[100:103], v62, s[32:35], 0 offen offset:0
  buffer_load_dwordx4 v[104:107], v62, s[32:35], 0 offen offset:128
  buffer_load_dwordx4 v[108:111], v62, s[32:35], 0 offen offset:256
  buffer_load_dwordx4 v[112:115], v62, s[32:35], 0 offen offset:384
  buffer_load_dwordx4 v[116:119], v62, s[32:35], 0 offen offset:512
  buffer_load_dwordx4 v[120:123], v62, s[32:35], 0 offen offset:640
  buffer_load_dwordx4 v[124:127], v62, s[32:35], 0 offen offset:768
KA_nostl:
  s_mul_i32 s46, s44, 4224
  s_mul_i32 s49, s41, 4608
  s_add_u32 s49, s49, 33280
  v_mov_b32 v16, 0
  v_mov_b32 v17, 0
  v_mov_b32 v18, 0
  v_mov_b32 v19, 0
  s_add_u32 s47, s49, 4096
  v_add_u32 v8, s47, v4
  s_mov_b32 exec_hi, 0
  ds_write_b128 v8, v[16:19]
  s_mov_b64 exec, -1
  v_and_b32 v10, 3, v2
  v_mul_u32_u24 v10, 4160, v10
  v_bfe_u32 v11, v2, 2, 1
  v_xor_b32 v11, 1, v11
  v_lshl_add_u32 v10, v11, 4, v10
  v_add_u32 v8, 32, v3
  v_lshrrev_b32 v20, 4, v2
  v_bfe_u32 v21, v2, 2, 2
  v_lshl_add_u32 v22, v20, 3, v21
  v_lshlrev_b32 v24, 7, v22
  v_lshrrev_b32 v21, 1, v21
  v_and_b32 v22, 1, v20
  v_lshl_or_b32 v21, v22, 1, v21
  v_xor_b32 v21, s40, v21
  v_lshl_add_u32 v24, v21, 5, v24
  v_and_b32 v22, 3, v2
  v_lshl_add_u32 v24, v22, 3, v24
  v_add_u32 v24, 75264, v24
  v_xor_b32 v25, 64, v24
  v_add_u32 v25, 1024, v25
  v_mul_u32_u24 v26, 4224, v14
  v_lshlrev_b32 v20, 4, v20
  s_lshl_b32 s52, s60, 7
  s_sub_u32 s53, 4080, s52
  v_sub_u32 v27, v26, v20
  v_add_u32 v27, s53, v27
  s_add_u32 s53, s52, 2097152
  v_add_u32 v28, v26, v20
  v_add_u32 v28, s53, v28
  v_subrev_u32 v29, 64, v27
  s_cmp_eq_u32 s54, 0xffff
  s_cbranch_scc1 KA_wo_filt0a
  s_waitcnt vmcnt(18)
  s_branch KA_wo_filt0b
KA_wo_filt0a:
  s_waitcnt vmcnt(11)
KA_wo_filt0b:
  ds_write_b128 v8, v[200:203] offset:4160
  ds_write_b128 v8, v[204:207] offset:12480
  v_alignbit_b32 v224, v200, v208, 16
  v_alignbit_b32 v225, v201, v200, 16
  v_alignbit_b32 v226, v202, v201, 16
  v_alignbit_b32 v227, v203, v202, 16
  v_alignbit_b32 v228, v201, v200, 16
  v_alignbit_b32 v229, v202, v201, 16
  v_alignbit_b32 v230, v203, v202, 16
  v_alignbit_b32 v231, v207, v203, 16
  ds_write_b128 v8, v[224:227] offset:0
  ds_write_b128 v8, v[228:231] offset:8320
  s_cmp_eq_u32 s54, 0xffff
  s_cbranch_scc1 KA_wo_filt1a
  s_waitcnt vmcnt(15)
  s_branch KA_wo_filt1b
KA_wo_filt1a:
  s_waitcnt vmcnt(8)
KA_wo_filt1b:
  ds_write_b128 v8, v[212:215] offset:20800
  ds_write_b128 v8, v[216:219] offset:29120
  v_alignbit_b32 v232, v212, v220, 16
  v_alignbit_b32 v233, v213, v212, 16
  v_alignbit_b32 v234, v214, v213, 16
  v_alignbit_b32 v235, v215, v214, 16
  v_alignbit_b32 v236, v213, v212, 16
  v_alignbit_b32 v237, v214, v213, 16
  v_alignbit_b32 v238, v215, v214, 16
  v_alignbit_b32 v239, v219, v215, 16
  ds_write_b128 v8, v[232:235] offset:16640
  ds_write_b128 v8, v[236:239] offset:24960
  s_cmp_lg_u32 s40, 0
  s_cbranch_scc1 KA_nohead
  v_readfirstlane_b32 s26, v208
  v_readfirstlane_b32 s27, v200
  v_mov_b32 v18, 0
  v_mov_b32 v19, 0
  s_nop 1
  s_lshl_b32 s33, s26, 16
  s_lshr_b32 s34, s26, 16
  s_lshl_b32 s35, s27, 16
  s_or_b32 s34, s34, s35
  v_writelane_b32 v18, s33, 2
  v_writelane_b32 v18, s26, 3
  v_writelane_b32 v19, s33, 0
  v_writelane_b32 v19, s26, 1
  v_writelane_b32 v19, s34, 2
  v_writelane_b32 v19, s27, 3
  s_mov_b64 exec, 0xff
  ds_write_b128 v10, v[16:19] offset:0
  s_mov_b64 exec, -1
  v_readfirstlane_b32 s26, v220
  v_readfirstlane_b32 s27, v212
  v_mov_b32 v18, 0
  v_mov_b32 v19, 0
  s_nop 1
  s_lshl_b32 s33, s26, 16
  s_lshr_b32 s34, s26, 16
  s_lshl_b32 s35, s27, 16
  s_or_b32 s34, s34, s35
  v_writelane_b32 v18, s33, 2
  v_writelane_b32 v18, s26, 3
  v_writelane_b32 v19, s33, 0
  v_writelane_b32 v19, s26, 1
  v_writelane_b32 v19, s34, 2
  v_writelane_b32 v19, s27, 3
  s_mov_b64 exec, 0xff
  ds_write_b128 v10, v[16:19] offset:16640
  s_mov_b64 exec, -1
KA_nohead:
  s_cmp_eq_u32 s54, 0xffff
  s_cbranch_scc1 KA_wo_t1a
  s_waitcnt vmcnt(7) lgkmcnt(0)
  s_branch KA_wo_t1b
KA_wo_t1a:
  s_waitcnt vmcnt(0) lgkmcnt(0)
KA_wo_t1b:
  s_barrier
  s_cmp_eq_u32 s40, 3
  s_cbranch_scc1 KB_nozf
  v_mov_b32 v60, 0
  global_load_dword v60, v60, s[22:23] sc1
KB_nozf:
  ds_read_b64_tr_b16 v[32:33], v24 offset:512
  ds_read_b64_tr_b16 v[34:35], v25 offset:0
  ds_read_b64_tr_b16 v[36:37], v25 offset:512
  ds_read_b64_tr_b16 v[38:39], v24 offset:9216
  ds_read_b64_tr_b16 v[40:41], v24 offset:9728
  ds_read_b64_tr_b16 v[42:43], v24 offset:17408
  ds_read_b64_tr_b16 v[44:45], v24 offset:17920
  ds_read_b64_tr_b16 v[46:47], v24 offset:4608
  ds_read_b64_tr_b16 v[48:49], v25 offset:4096
  ds_read_b64_tr_b16 v[50:51], v25 offset:4608
  ds_read_b64_tr_b16 v[52:53], v24 offset:13312
  ds_read_b64_tr_b16 v[54:55], v24 offset:13824
  ds_read_b64_tr_b16 v[56:57], v24 offset:21504
  ds_read_b64_tr_b16 v[58:59], v24 offset:22016
  v_lshlrev_b32 v16, 16, v30
  v_and_b32 v17, 0xffff0000, v30
  v_lshlrev_b32 v18, 16, v31
  v_and_b32 v19, 0xffff0000, v31
  s_waitcnt lgkmcnt(7)
  buffer_store_dwordx4 v[42:45], v28, s[28:31], 0 offen offset:0 sc1
  v_and_b32 v64, 0xffff0000, v32
  v_lshlrev_b32 v65, 16, v33
  v_and_b32 v66, 0xffff0000, v33
  v_lshlrev_b32 v67, 16, v34
  v_and_b32 v68, 0xffff0000, v34
  v_lshlrev_b32 v69, 16, v35
  v_and_b32 v70, 0xffff0000, v35
  v_lshlrev_b32 v71, 16, v36
  v_and_b32 v72, 0xffff0000, v36
  v_lshlrev_b32 v73, 16, v37
  v_and_b32 v74, 0xffff0000, v37
  v_lshlrev_b32 v76, 16, v38
  v_and_b32 v77, 0xffff0000, v38
  v_lshlrev_b32 v78, 16, v39
  v_and_b32 v79, 0xffff0000, v39
  v_lshlrev_b32 v80, 16, v40
  v_and_b32 v81, 0xffff0000, v40
  v_lshlrev_b32 v82, 16, v41
  v_and_b32 v83, 0xffff0000, v41
  v_mul_f32 v84, v19, v64
  v_mul_f32 v85, v19, v65
  v_mul_f32 v86, v19, v66
  v_mul_f32 v87, v19, v67
  v_mul_f32 v88, v19, v68
  v_mul_f32 v89, v19, v69
  v_mul_f32 v90, v19, v70
  v_mul_f32 v91, v19, v71
  v_fmac_f32 v84, v18, v65
  v_fmac_f32 v85, v18, v66
  v_fmac_f32 v86, v18, v67
  v_fmac_f32 v87, v18, v68
  v_fmac_f32 v88, v18, v69
  v_fmac_f32 v89, v18, v70
  v_fmac_f32 v90, v18, v71
  v_fmac_f32 v91, v18, v72
  v_fmac_f32 v84, v17, v66
  v_fmac_f32 v85, v17, v67
  v_fmac_f32 v86, v17, v68
  v_fmac_f32 v87, v17, v69
  v_fmac_f32 v88, v17, v70
  v_fmac_f32 v89, v17, v71
  v_fmac_f32 v90, v17, v72
  v_fmac_f32 v91, v17, v73
  v_fmac_f32 v84, v16, v67
  v_fmac_f32 v85, v16, v68
  v_fmac_f32 v86, v16, v69
  v_fmac_f32 v87, v16, v70
  v_fmac_f32 v88, v16, v71
  v_fmac_f32 v89, v16, v72
  v_fmac_f32 v90, v16, v73
  v_fmac_f32 v91, v16, v74
  v_mul_f32 v84, v84, v76
  v_mul_f32 v85, v85, v77
  v_mul_f32 v86, v86, v78
  v_mul_f32 v87, v87, v79
  v_mul_f32 v88, v88, v80
  v_mul_f32 v89, v89, v81
  v_mul_f32 v90, v90, v82
  v_mul_f32 v91, v91, v83
  v_cvt_pk_bf16_f32 v92, v91, v90
  v_cvt_pk_bf16_f32 v93, v89, v88
  v_cvt_pk_bf16_f32 v94, v87, v86
  v_cvt_pk_bf16_f32 v95, v85, v84
  buffer_store_dwordx4 v[92:95], v27, s[28:31], 0 offen sc1
  s_waitcnt lgkmcnt(0)
  buffer_store_dwordx4 v[56:59], v28, s[28:31], 0 offen offset:64 sc1
  v_and_b32 v64, 0xffff0000, v46
  v_lshlrev_b32 v65, 16, v47
  v_and_b32 v66, 0xffff0000, v47
  v_lshlrev_b32 v67, 16, v48
  v_and_b32 v68, 0xffff0000, v48
  v_lshlrev_b32 v69, 16, v49
  v_and_b32 v70, 0xffff0000, v49
  v_lshlrev_b32 v71, 16, v50
  v_and_b32 v72, 0xffff0000, v50
  v_lshlrev_b32 v73, 16, v51
  v_and_b32 v74, 0xffff0000, v51
  v_lshlrev_b32 v76, 16, v52
  v_and_b32 v77, 0xffff0000, v52
  v_lshlrev_b32 v78, 16, v53
  v_and_b32 v79, 0xffff0000, v53
  v_lshlrev_b32 v80, 16, v54
  v_and_b32 v81, 0xffff0000, v54
  v_lshlrev_b32 v82, 16, v55
  v_and_b32 v83, 0xffff0000, v55
  v_mul_f32 v84, v19, v64
  v_mul_f32 v85, v19, v65
  v_mul_f32 v86, v19, v66
  v_mul_f32 v87, v19, v67
  v_mul_f32 v88, v19, v68
  v_mul_f32 v89, v19, v69
  v_mul_f32 v90, v19, v70
  v_mul_f32 v91, v19, v71
  v_fmac_f32 v84, v18, v65
  v_fmac_f32 v85, v18, v66
  v_fmac_f32 v86, v18, v67
  v_fmac_f32 v87, v18, v68
  v_fmac_f32 v88, v18, v69
  v_fmac_f32 v89, v18, v70
  v_fmac_f32 v90, v18, v71
  v_fmac_f32 v91, v18, v72
  v_fmac_f32 v84, v17, v66
  v_fmac_f32 v85, v17, v67
  v_fmac_f32 v86, v17, v68
  v_fmac_f32 v87, v17, v69
  v_fmac_f32 v88, v17, v70
  v_fmac_f32 v89, v17, v71
  v_fmac_f32 v90, v17, v72
  v_fmac_f32 v91, v17, v73
  v_fmac_f32 v84, v16, v67
  v_fmac_f32 v85, v16, v68
  v_fmac_f32 v86, v16, v69
  v_fmac_f32 v87, v16, v70
  v_fmac_f32 v88, v16, v71
  v_fmac_f32 v89, v16, v72
  v_fmac_f32 v90, v16, v73
  v_fmac_f32 v91, v16, v74
  v_mul_f32 v84, v84, v76
  v_mul_f32 v85, v85, v77
  v_mul_f32 v86, v86, v78
  v_mul_f32 v87, v87, v79
  v_mul_f32 v88, v88, v80
  v_mul_f32 v89, v89, v81
  v_mul_f32 v90, v90, v82
  v_mul_f32 v91, v91, v83
  v_cvt_pk_bf16_f32 v96, v91, v90
  v_cvt_pk_bf16_f32 v97, v89, v88
  v_cvt_pk_bf16_f32 v98, v87, v86
  v_cvt_pk_bf16_f32 v99, v85, v84
  buffer_store_dwordx4 v[96:99], v29, s[28:31], 0 offen sc1
  v_and_b32 v5, 15, v2
  v_lshrrev_b32 v6, 4, v2
  v_lshlrev_b32 v7, 5, v5
  v_lshl_add_u32 v7, v6, 3, v7
  v_bfe_u32 v9, v2, 2, 2
  v_mul_u32_u24 v12, 4160, v9
  v_and_b32 v9, 3, v2
  v_lshl_add_u32 v12, v9, 3, v12
  v_lshlrev_b32 v9, 4, v6
  v_sub_u32 v12, v12, v9
  s_mul_i32 s47, s41, 16640
  s_lshl_b32 s51, s42, 8
  s_add_u32 s47, s47, s51
  s_add_u32 s47, s47, 48
  v_add_u32 v12, s47, v12
  v_lshlrev_b32 v13, 5, v5
  v_add_u32 v13, v13, v9
  s_add_u32 s47, s49, s51
  s_add_u32 s47, s47, 528
  v_sub_u32 v13, s47, v13
  v_lshlrev_b32 v252, 8, v2
  v_and_b32 v253, 3, v2
  v_lshlrev_b32 v253, 8, v253
  s_waitcnt vmcnt(0) lgkmcnt(0)
  s_barrier
  s_cmp_eq_u32 s40, 0
  s_cbranch_scc1 KE_pol0
  s_cmp_eq_u32 s54, 0xffff
  s_cbranch_scc1 KA_nost
  s_mov_b32 s47, 0x3f803f80
  v_mov_b32 v64, 0
  v_mov_b32 v65, 0
  v_mov_b32 v66, 0
  v_mov_b32 v67, 0
  v_dot2_f32_bf16 v64, v100, s47, v64
  v_dot2_f32_bf16 v65, v100, v100, v65
  v_dot2_f32_bf16 v66, v101, s47, v66
  v_dot2_f32_bf16 v67, v101, v101, v67
  v_dot2_f32_bf16 v64, v102, s47, v64
  v_dot2_f32_bf16 v65, v102, v102, v65
  v_dot2_f32_bf16 v66, v103, s47, v66
  v_dot2_f32_bf16 v67, v103, v103, v67
  v_dot2_f32_bf16 v64, v104, s47, v64
  v_dot2_f32_bf16 v65, v104, v104, v65
  v_dot2_f32_bf16 v66, v105, s47, v66
  v_dot2_f32_bf16 v67, v105, v105, v67
  v_dot2_f32_bf16 v64, v106, s47, v64
  v_dot2_f32_bf16 v65, v106, v106, v65
  v_dot2_f32_bf16 v66, v107, s47, v66
  v_dot2_f32_bf16 v67, v107, v107, v67
  v_dot2_f32_bf16 v64, v108, s47, v64
  v_dot2_f32_bf16 v65, v108, v108, v65
  v_dot2_f32_bf16 v66, v109, s47, v66
  v_dot2_f32_bf16 v67, v109, v109, v67
  v_dot2_f32_bf16 v64, v110, s47, v64
  v_dot2_f32_bf16 v65, v110, v110, v65
  v_dot2_f32_bf16 v66, v111, s47, v66
  v_dot2_f32_bf16 v67, v111, v111, v67
  v_dot2_f32_bf16 v64, v112, s47, v64
  v_dot2_f32_bf16 v65, v112, v112, v65
  v_dot2_f32_bf16 v66, v113, s47, v66
  v_dot2_f32_bf16 v67, v113, v113, v67
  v_dot2_f32_bf16 v64, v114, s47, v64
  v_dot2_f32_bf16 v65, v114, v114, v65
  v_dot2_f32_bf16 v66, v115, s47, v66
  v_dot2_f32_bf16 v67, v115, v115, v67
  v_dot2_f32_bf16 v64, v116, s47, v64
  v_dot2_f32_bf16 v65, v116, v116, v65
  v_dot2_f32_bf16 v66, v117, s47, v66
  v_dot2_f32_bf16 v67, v117, v117, v67
  v_dot2_f32_bf16 v64, v118, s47, v64
  v_dot2_f32_bf16 v65, v118, v118, v65
  v_dot2_f32_bf16 v66, v119, s47, v66
  v_dot2_f32_bf16 v67, v119, v119, v67
  v_dot2_f32_bf16 v64, v120, s47, v64
  v_dot2_f32_bf16 v65, v120, v120, v65
  v_dot2_f32_bf16 v66, v121, s47, v66
  v_dot2_f32_bf16 v67, v121, v121, v67
  v_dot2_f32_bf16 v64, v122, s47, v64
  v_dot2_f32_bf16 v65, v122, v122, v65
  v_dot2_f32_bf16 v66, v123, s47, v66
  v_dot2_f32_bf16 v67, v123, v123, v67
  v_dot2_f32_bf16 v64, v124, s47, v64
  v_dot2_f32_bf16 v65, v124, v124, v65
  v_dot2_f32_bf16 v66, v125, s47, v66
  v_dot2_f32_bf16 v67, v125, v125, v67
  v_dot2_f32_bf16 v64, v126, s47, v64
  v_dot2_f32_bf16 v65, v126, v126, v65
  v_dot2_f32_bf16 v66, v127, s47, v66
  v_dot2_f32_bf16 v67, v127, v127, v67
  s_nop 2
  v_add_f32 v64, v64, v66
  v_add_f32 v66, v65, v67
  s_nop 1
  v_add_f32_dpp v64, v64, v64 quad_perm:[1,0,3,2] row_mask:0xf bank_mask:0xf
  v_add_f32_dpp v66, v66, v66 quad_perm:[1,0,3,2] row_mask:0xf bank_mask:0xf
  s_nop 1
  v_add_f32_dpp v64, v64, v64 quad_perm:[2,3,0,1] row_mask:0xf bank_mask:0xf
  v_add_f32_dpp v66, v66, v66 quad_perm:[2,3,0,1] row_mask:0xf bank_mask:0xf
  s_nop 1
  v_add_f32_dpp v64, v64, v64 row_half_mirror row_mask:0xf bank_mask:0xf
  v_add_f32_dpp v66, v66, v66 row_half_mirror row_mask:0xf bank_mask:0xf
  s_mov_b32 s47, 0x3b124925
  v_mul_f32 v64, s47, v64
  v_mul_f32 v70, v64, v64
  v_fma_f32 v66, v66, s47, -v70
  v_max_f32 v66, 0, v66
  v_cvt_pk_bf16_f32 v66, v66, v66
  v_lshlrev_b32 v66, 16, v66
  v_add_f32 v66, 0x3727c5ac, v66
  v_cvt_pk_bf16_f32 v66, v66, v66
  v_lshlrev_b32 v66, 16, v66
  v_sqrt_f32 v70, v66
  s_nop 0
  v_cvt_pk_bf16_f32 v70, v70, v70
  v_lshlrev_b32 v70, 16, v70
  v_rcp_f32 v68, v70
  v_cvt_pk_bf16_f32 v64, v64, v64
  v_lshlrev_b32 v64, 16, v64
  v_mul_f32 v69, v64, v68
  v_sub_f32 v69, 0, v69
  v_lshlrev_b32 v20, 2, v61
  v_add_u32 v20, 4194304, v20
  buffer_store_dword v68, v20, s[28:31], 0 offen sc1
  v_add_u32 v21, 8192, v20
  buffer_store_dword v69, v21, s[28:31], 0 offen sc1
  s_waitcnt vmcnt(0)
  v_mov_b32 v10, 0
  v_readfirstlane_b32 s62, v60
  s_nop 3
  s_cmp_eq_u32 s62, 1
  s_cbranch_scc1 KE_zs_ok
  s_mov_b32 s63, 65536
KE_zs_l:
  global_load_dword v11, v10, s[22:23] sc1
  s_waitcnt vmcnt(0)
  v_readfirstlane_b32 s62, v11
  s_nop 3
  s_cmp_eq_u32 s62, 1
  s_cbranch_scc1 KE_zs_g
  s_sleep 2
  s_sub_u32 s63, s63, 1
  s_cmp_lg_u32 s63, 0
  s_cbranch_scc1 KE_zs_l
KE_zs_g:
KE_zs_ok:
  s_lshl_b32 s62, s60, 3
  s_add_u32 s62, s62, s54
  s_and_b32 s62, s62, 63
  s_lshl_b32 s62, s62, 8
  s_add_u32 s62, s62, 20185088
  s_mov_b64 exec, 1
  v_mov_b32 v11, 1
  buffer_atomic_add v11, v10, s[28:31], s62 offen sc1
  s_mov_b64 exec, -1
KA_nost:
  s_branch KB_w0
KE_pol0:
  v_readfirstlane_b32 s62, v60
  s_nop 3
  s_cmp_eq_u32 s62, 1
  s_cbranch_scc1 KB_zok
  v_mov_b32 v10, 0
  s_mov_b32 s63, 65536
KB_z0_l:
  global_load_dword v11, v10, s[22:23] sc1
  s_waitcnt vmcnt(0)
  v_readfirstlane_b32 s62, v11
  s_nop 3
  s_cmp_eq_u32 s62, 1
  s_cbranch_scc1 KB_z0_g
  s_sleep 2
  s_sub_u32 s63, s63, 1
  s_cmp_lg_u32 s63, 0
  s_cbranch_scc1 KB_z0_l
KB_z0_g:
KB_zok:
  s_lshl_b32 s62, s61, 3
  s_and_b32 s63, s60, 7
  s_add_u32 s62, s62, s63
  s_lshl_b32 s62, s62, 8
  s_add_u32 s62, s62, 20217856
  s_mov_b64 exec, 1
  v_mov_b32 v10, 0
  v_mov_b32 v11, 1
  buffer_atomic_add v11, v10, s[28:31], s62 offen sc1
  s_mov_b64 exec, -1
  s_lshr_b32 s62, s2, 5
  s_lshl_b32 s62, s62, 11
  s_add_u32 s62, s62, 20217856
  v_and_b32 v9, 7, v2
  v_lshlrev_b32 v9, 8, v9
  v_mov_b32 v10, 4
  s_mov_b32 s63, 65536
  s_sleep 6
  buffer_load_dword v255, v9, s[28:31], s62 offen sc1
KB_p0_l:
  s_sleep 4
  buffer_load_dword v254, v9, s[28:31], s62 offen sc1
  s_waitcnt vmcnt(1)
  v_cmp_gt_u32 vcc, v10, v255
  s_nop 4
  s_cmp_eq_u64 vcc, 0
  s_cbranch_scc1 KB_p0_g
  s_sleep 4
  buffer_load_dword v255, v9, s[28:31], s62 offen sc1
  s_waitcnt vmcnt(1)
  v_cmp_gt_u32 vcc, v10, v254
  s_nop 4
  s_cmp_eq_u64 vcc, 0
  s_cbranch_scc1 KB_p0_g
  s_sub_u32 s63, s63, 1
  s_cmp_lg_u32 s63, 0
  s_cbranch_scc1 KB_p0_l
KB_p0_g:
KB_w0:
  s_barrier
  s_lshl_b32 s47, s42, 11
  s_add_u32 s48, s46, s47
  s_add_u32 s48, s48, 0
  s_add_u32 m0, s49, s47
  s_nop 0
  buffer_load_dwordx4 v4, s[28:31], s48 offen sc1 lds
  buffer_load_dwordx4 v4, s[28:31], s48 offen offset:1024 sc1 lds
  s_lshl_b32 s47, s42, 10
  s_add_u32 s48, s46, s47
  s_add_u32 s48, s48, 2097152
  buffer_load_dwordx2 v[176:177], v7, s[28:31], s48 offen offset:0 sc1
  buffer_load_dwordx2 v[178:179], v7, s[28:31], s48 offen offset:512 sc1
  buffer_load_dwordx2 v[180:181], v7, s[28:31], s48 offen offset:2048 sc1
  buffer_load_dwordx2 v[182:183], v7, s[28:31], s48 offen offset:2560 sc1
  s_lshl_b32 s52, s57, 2
  s_add_u32 s52, s52, s40
  s_mul_i32 s52, s52, 28672
  s_add_u32 s52, s52, 7340032
  s_cmp_eq_u32 s40, 0
  s_cbranch_scc1 KB_now2i
  s_mov_b32 s36, s18
  s_mov_b32 s37, s19
  s_mov_b32 s38, 1605632
  s_mov_b32 s39, 0x20000
  s_lshr_b32 s67, s2, 1
  s_mul_i32 s67, s67, 14336
  s_and_b32 s68, s2, 1
  s_mul_i32 s69, s68, 448
  s_add_u32 s67, s67, s69
  s_sub_u32 s69, s40, 1
  s_lshl_b32 s47, s69, 6
  s_add_u32 s67, s67, s47
  v_lshrrev_b32 v10, 2, v2
  v_mul_u32_u24 v10, 896, v10
  v_and_b32 v11, 3, v2
  v_lshl_add_u32 v10, v11, 4, v10
  s_mul_i32 s47, s69, 3072
  s_add_u32 m0, s47, 100864
  s_add_u32 s69, s67, 192
  buffer_load_dwordx4 v10, s[36:39], s67 offen lds
  s_add_u32 m0, m0, 1024
  s_add_u32 s67, s67, 384
  buffer_load_dwordx4 v10, s[36:39], s69 offen lds
  s_add_u32 m0, m0, 1024
  s_nop 0
  buffer_load_dwordx4 v10, s[36:39], s67 offen lds
KB_now2i:
  s_mul_i32 s60, s40, 28672
  s_mul_i32 s61, s59, 229376
  s_add_u32 s60, s60, s61
  s_add_u32 s60, s60, 9437184
  s_add_u32 s61, s60, 114688
  v_lshlrev_b32 v14, 5, v5
  v_lshl_add_u32 v14, v6, 3, v14
  s_lshl_b32 s47, s42, 10
  s_sub_u32 s47, s49, s47
  s_add_u32 s47, s47, 1528
  v_sub_u32 v14, s47, v14
  v_lshlrev_b32 v15, 6, v5
  v_lshl_add_u32 v15, v6, 4, v15
  s_lshl_b32 s47, s42, 11
  s_add_u32 s47, s47, 42496
  v_add_u32 v15, s47, v15
  s_lshl_b32 s47, s40, 11
  s_add_u32 s47, s47, 58880
  v_add_u32 v189, s47, v4
  s_xor_b32 s47, s40, 2
  s_lshl_b32 s47, s47, 11
  s_add_u32 s47, s47, 58880
  v_add_u32 v190, s47, v4
  v_lshrrev_b32 v8, 1, v5
  v_mul_u32_u24 v8, 28672, v8
  v_and_b32 v9, 1, v5
  v_lshl_add_u32 v8, v9, 5, v8
  v_lshl_add_u32 v8, v6, 3, v8
  s_lshl_b32 s47, s44, 6
  v_add_u32 v8, s47, v8
  s_mul_i32 s50, s42, 458752
  s_add_u32 s50, s50, 5242880
  s_waitcnt vmcnt(4)
  s_barrier
  s_cmp_lg_u32 s40, 0
  s_cbranch_scc1 KE_ist_i
  s_mov_b32 s62, 20185088
  buffer_load_dword v255, v252, s[28:31], s62 offen sc1
KE_ist_i:
  s_cmp_lg_u32 s40, 0
  s_cbranch_scc1 KB_iw1b_i
  s_mov_b32 s62, 20267008
  buffer_load_dword v254, v253, s[28:31], s62 offen sc1
KB_iw1b_i:
  ds_read_b128 v[80:83], v13 offset:3584
  ds_read_b64_tr_b16 v[48:49], v12 offset:0
  ds_read_b64_tr_b16 v[50:51], v12 offset:8
  ds_read_b64_tr_b16 v[52:53], v12 offset:512
  ds_read_b64_tr_b16 v[54:55], v12 offset:520
  ds_read_b64_tr_b16 v[56:57], v12 offset:1024
  ds_read_b64_tr_b16 v[58:59], v12 offset:1032
  ds_read_b64_tr_b16 v[60:61], v12 offset:1536
  ds_read_b64_tr_b16 v[62:63], v12 offset:1544
  ds_read_b64_tr_b16 v[64:65], v12 offset:2048
  ds_read_b64_tr_b16 v[66:67], v12 offset:2056
  ds_read_b64_tr_b16 v[68:69], v12 offset:2560
  ds_read_b64_tr_b16 v[70:71], v12 offset:2568
  ds_read_b64_tr_b16 v[72:73], v12 offset:3072
  ds_read_b64_tr_b16 v[74:75], v12 offset:3080
  ds_read_b64_tr_b16 v[76:77], v12 offset:3584
  ds_read_b64_tr_b16 v[78:79], v12 offset:3592
  ds_read_b128 v[84:87], v13 offset:3072
  ds_read_b128 v[88:91], v13 offset:2560
  ds_read_b128 v[92:95], v13 offset:2048
  ds_read_b128 v[96:99], v13 offset:1536
  ds_read_b128 v[100:103], v13 offset:1024
  ds_read_b128 v[104:107], v13 offset:512
  ds_read_b128 v[108:111], v13 offset:0
  s_waitcnt lgkmcnt(0)
  v_mfma_f32_16x16x32_bf16 v[16:19], v[48:51], v[80:83], 0
  ds_read_b128 v[144:147], v13 offset:3648
  v_mfma_f32_16x16x32_bf16 v[20:23], v[52:55], v[80:83], 0
  ds_read_b64_tr_b16 v[112:113], v12 offset:64
  v_mfma_f32_16x16x32_bf16 v[24:27], v[56:59], v[80:83], 0
  ds_read_b64_tr_b16 v[114:115], v12 offset:72
  v_mfma_f32_16x16x32_bf16 v[28:31], v[60:63], v[80:83], 0
  ds_read_b64_tr_b16 v[116:117], v12 offset:576
  v_mfma_f32_16x16x32_bf16 v[32:35], v[64:67], v[80:83], 0
  ds_read_b64_tr_b16 v[118:119], v12 offset:584
  v_mfma_f32_16x16x32_bf16 v[36:39], v[68:71], v[80:83], 0
  ds_read_b64_tr_b16 v[120:121], v12 offset:1088
  v_mfma_f32_16x16x32_bf16 v[40:43], v[72:75], v[80:83], 0
  ds_read_b64_tr_b16 v[122:123], v12 offset:1096
  v_mfma_f32_16x16x32_bf16 v[44:47], v[76:79], v[80:83], 0
  ds_read_b64_tr_b16 v[124:125], v12 offset:1600
  v_mfma_f32_16x16x32_bf16 v[20:23], v[48:51], v[84:87], v[20:23]
  ds_read_b64_tr_b16 v[126:127], v12 offset:1608
  v_mfma_f32_16x16x32_bf16 v[24:27], v[52:55], v[84:87], v[24:27]
  ds_read_b64_tr_b16 v[128:129], v12 offset:2112
  v_mfma_f32_16x16x32_bf16 v[28:31], v[56:59], v[84:87], v[28:31]
  ds_read_b64_tr_b16 v[130:131], v12 offset:2120
  v_mfma_f32_16x16x32_bf16 v[32:35], v[60:63], v[84:87], v[32:35]
  ds_read_b64_tr_b16 v[132:133], v12 offset:2624
  v_mfma_f32_16x16x32_bf16 v[36:39], v[64:67], v[84:87], v[36:39]
  ds_read_b64_tr_b16 v[134:135], v12 offset:2632
  v_mfma_f32_16x16x32_bf16 v[40:43], v[68:71], v[84:87], v[40:43]
  ds_read_b64_tr_b16 v[136:137], v12 offset:3136
  v_mfma_f32_16x16x32_bf16 v[44:47], v[72:75], v[84:87], v[44:47]
  ds_read_b64_tr_b16 v[138:139], v12 offset:3144
  v_mfma_f32_16x16x32_bf16 v[24:27], v[48:51], v[88:91], v[24:27]
  ds_read_b64_tr_b16 v[140:141], v12 offset:3648
  v_mfma_f32_16x16x32_bf16 v[28:31], v[52:55], v[88:91], v[28:31]
  ds_read_b64_tr_b16 v[142:143], v12 offset:3656
  v_mfma_f32_16x16x32_bf16 v[32:35], v[56:59], v[88:91], v[32:35]
  ds_read_b128 v[148:151], v13 offset:3136
  v_mfma_f32_16x16x32_bf16 v[36:39], v[60:63], v[88:91], v[36:39]
  ds_read_b128 v[152:155], v13 offset:2624
  v_mfma_f32_16x16x32_bf16 v[40:43], v[64:67], v[88:91], v[40:43]
  ds_read_b128 v[156:159], v13 offset:2112
  v_mfma_f32_16x16x32_bf16 v[44:47], v[68:71], v[88:91], v[44:47]
  ds_read_b128 v[160:163], v13 offset:1600
  v_mfma_f32_16x16x32_bf16 v[28:31], v[48:51], v[92:95], v[28:31]
  ds_read_b128 v[164:167], v13 offset:1088
  v_mfma_f32_16x16x32_bf16 v[32:35], v[52:55], v[92:95], v[32:35]
  ds_read_b128 v[168:171], v13 offset:576
  v_mfma_f32_16x16x32_bf16 v[36:39], v[56:59], v[92:95], v[36:39]
  ds_read_b128 v[172:175], v13 offset:64
  v_mfma_f32_16x16x32_bf16 v[40:43], v[60:63], v[92:95], v[40:43]
  v_mfma_f32_16x16x32_bf16 v[44:47], v[64:67], v[92:95], v[44:47]
  v_mfma_f32_16x16x32_bf16 v[32:35], v[48:51], v[96:99], v[32:35]
  v_mfma_f32_16x16x32_bf16 v[36:39], v[52:55], v[96:99], v[36:39]
  v_mfma_f32_16x16x32_bf16 v[40:43], v[56:59], v[96:99], v[40:43]
  v_mfma_f32_16x16x32_bf16 v[44:47], v[60:63], v[96:99], v[44:47]
  v_mfma_f32_16x16x32_bf16 v[36:39], v[48:51], v[100:103], v[36:39]
  v_mfma_f32_16x16x32_bf16 v[40:43], v[52:55], v[100:103], v[40:43]
  v_mfma_f32_16x16x32_bf16 v[44:47], v[56:59], v[100:103], v[44:47]
  v_mfma_f32_16x16x32_bf16 v[40:43], v[48:51], v[104:107], v[40:43]
  v_mfma_f32_16x16x32_bf16 v[44:47], v[52:55], v[104:107], v[44:47]
  v_mfma_f32_16x16x32_bf16 v[44:47], v[48:51], v[108:111], v[44:47]
  s_waitcnt lgkmcnt(0)
  v_mfma_f32_16x16x32_bf16 v[16:19], v[112:115], v[144:147], v[16:19]
  ds_read_b128 v[80:83], v13 offset:3712
  v_mfma_f32_16x16x32_bf16 v[20:23], v[116:119], v[144:147], v[20:23]
  ds_read_b64_tr_b16 v[48:49], v12 offset:128
  v_mfma_f32_16x16x32_bf16 v[24:27], v[120:123], v[144:147], v[24:27]
  ds_read_b64_tr_b16 v[50:51], v12 offset:136
  v_mfma_f32_16x16x32_bf16 v[28:31], v[124:127], v[144:147], v[28:31]
  ds_read_b64_tr_b16 v[52:53], v12 offset:640
  v_mfma_f32_16x16x32_bf16 v[32:35], v[128:131], v[144:147], v[32:35]
  ds_read_b64_tr_b16 v[54:55], v12 offset:648
  v_mfma_f32_16x16x32_bf16 v[36:39], v[132:135], v[144:147], v[36:39]
  ds_read_b64_tr_b16 v[56:57], v12 offset:1152
  v_mfma_f32_16x16x32_bf16 v[40:43], v[136:139], v[144:147], v[40:43]
  ds_read_b64_tr_b16 v[58:59], v12 offset:1160
  v_mfma_f32_16x16x32_bf16 v[44:47], v[140:143], v[144:147], v[44:47]
  ds_read_b64_tr_b16 v[60:61], v12 offset:1664
  v_mfma_f32_16x16x32_bf16 v[20:23], v[112:115], v[148:151], v[20:23]
  ds_read_b64_tr_b16 v[62:63], v12 offset:1672
  v_mfma_f32_16x16x32_bf16 v[24:27], v[116:119], v[148:151], v[24:27]
  ds_read_b64_tr_b16 v[64:65], v12 offset:2176
  v_mfma_f32_16x16x32_bf16 v[28:31], v[120:123], v[148:151], v[28:31]
  ds_read_b64_tr_b16 v[66:67], v12 offset:2184
  v_mfma_f32_16x16x32_bf16 v[32:35], v[124:127], v[148:151], v[32:35]
  ds_read_b64_tr_b16 v[68:69], v12 offset:2688
  v_mfma_f32_16x16x32_bf16 v[36:39], v[128:131], v[148:151], v[36:39]
  ds_read_b64_tr_b16 v[70:71], v12 offset:2696
  v_mfma_f32_16x16x32_bf16 v[40:43], v[132:135], v[148:151], v[40:43]
  ds_read_b64_tr_b16 v[72:73], v12 offset:3200
  v_mfma_f32_16x16x32_bf16 v[44:47], v[136:139], v[148:151], v[44:47]
  ds_read_b64_tr_b16 v[74:75], v12 offset:3208
  v_mfma_f32_16x16x32_bf16 v[24:27], v[112:115], v[152:155], v[24:27]
  ds_read_b64_tr_b16 v[76:77], v12 offset:3712
  v_mfma_f32_16x16x32_bf16 v[28:31], v[116:119], v[152:155], v[28:31]
  ds_read_b64_tr_b16 v[78:79], v12 offset:3720
  v_mfma_f32_16x16x32_bf16 v[32:35], v[120:123], v[152:155], v[32:35]
  ds_read_b128 v[84:87], v13 offset:3200
  v_mfma_f32_16x16x32_bf16 v[36:39], v[124:127], v[152:155], v[36:39]
  ds_read_b128 v[88:91], v13 offset:2688
  v_mfma_f32_16x16x32_bf16 v[40:43], v[128:131], v[152:155], v[40:43]
  ds_read_b128 v[92:95], v13 offset:2176
  v_mfma_f32_16x16x32_bf16 v[44:47], v[132:135], v[152:155], v[44:47]
  ds_read_b128 v[96:99], v13 offset:1664
  v_mfma_f32_16x16x32_bf16 v[28:31], v[112:115], v[156:159], v[28:31]
  ds_read_b128 v[100:103], v13 offset:1152
  v_mfma_f32_16x16x32_bf16 v[32:35], v[116:119], v[156:159], v[32:35]
  ds_read_b128 v[104:107], v13 offset:640
  v_mfma_f32_16x16x32_bf16 v[36:39], v[120:123], v[156:159], v[36:39]
  ds_read_b128 v[108:111], v13 offset:128
  v_mfma_f32_16x16x32_bf16 v[40:43], v[124:127], v[156:159], v[40:43]
  v_mfma_f32_16x16x32_bf16 v[44:47], v[128:131], v[156:159], v[44:47]
  v_mfma_f32_16x16x32_bf16 v[32:35], v[112:115], v[160:163], v[32:35]
  v_mfma_f32_16x16x32_bf16 v[36:39], v[116:119], v[160:163], v[36:39]
  v_mfma_f32_16x16x32_bf16 v[40:43], v[120:123], v[160:163], v[40:43]
  v_mfma_f32_16x16x32_bf16 v[44:47], v[124:127], v[160:163], v[44:47]
  v_mfma_f32_16x16x32_bf16 v[36:39], v[112:115], v[164:167], v[36:39]
  v_mfma_f32_16x16x32_bf16 v[40:43], v[116:119], v[164:167], v[40:43]
  v_mfma_f32_16x16x32_bf16 v[44:47], v[120:123], v[164:167], v[44:47]
  v_mfma_f32_16x16x32_bf16 v[40:43], v[112:115], v[168:171], v[40:43]
  v_mfma_f32_16x16x32_bf16 v[44:47], v[116:119], v[168:171], v[44:47]
  v_mfma_f32_16x16x32_bf16 v[44:47], v[112:115], v[172:175], v[44:47]
  s_cmp_lg_u32 s40, 0
  s_cbranch_scc1 KE_ist2_i
  s_mov_b32 s62, 20185088
  buffer_load_dword v251, v252, s[28:31], s62 offen sc1
KE_ist2_i:
  s_waitcnt lgkmcnt(0)
  v_mfma_f32_16x16x32_bf16 v[16:19], v[48:51], v[80:83], v[16:19]
  ds_read_b128 v[144:147], v13 offset:3776
  v_mfma_f32_16x16x32_bf16 v[20:23], v[52:55], v[80:83], v[20:23]
  ds_read_b64_tr_b16 v[112:113], v12 offset:192
  v_mfma_f32_16x16x32_bf16 v[24:27], v[56:59], v[80:83], v[24:27]
  ds_read_b64_tr_b16 v[114:115], v12 offset:200
  v_mfma_f32_16x16x32_bf16 v[28:31], v[60:63], v[80:83], v[28:31]
  ds_read_b64_tr_b16 v[116:117], v12 offset:704
  v_mfma_f32_16x16x32_bf16 v[32:35], v[64:67], v[80:83], v[32:35]
  ds_read_b64_tr_b16 v[118:119], v12 offset:712
  v_mfma_f32_16x16x32_bf16 v[36:39], v[68:71], v[80:83], v[36:39]
  ds_read_b64_tr_b16 v[120:121], v12 offset:1216
  v_mfma_f32_16x16x32_bf16 v[40:43], v[72:75], v[80:83], v[40:43]
  ds_read_b64_tr_b16 v[122:123], v12 offset:1224
  v_mfma_f32_16x16x32_bf16 v[44:47], v[76:79], v[80:83], v[44:47]
  ds_read_b64_tr_b16 v[124:125], v12 offset:1728
  v_mfma_f32_16x16x32_bf16 v[20:23], v[48:51], v[84:87], v[20:23]
  ds_read_b64_tr_b16 v[126:127], v12 offset:1736
  v_mfma_f32_16x16x32_bf16 v[24:27], v[52:55], v[84:87], v[24:27]
  ds_read_b64_tr_b16 v[128:129], v12 offset:2240
  v_mfma_f32_16x16x32_bf16 v[28:31], v[56:59], v[84:87], v[28:31]
  ds_read_b64_tr_b16 v[130:131], v12 offset:2248
  v_mfma_f32_16x16x32_bf16 v[32:35], v[60:63], v[84:87], v[32:35]
  ds_read_b64_tr_b16 v[132:133], v12 offset:2752
  v_mfma_f32_16x16x32_bf16 v[36:39], v[64:67], v[84:87], v[36:39]
  ds_read_b64_tr_b16 v[134:135], v12 offset:2760
  v_mfma_f32_16x16x32_bf16 v[40:43], v[68:71], v[84:87], v[40:43]
  ds_read_b64_tr_b16 v[136:137], v12 offset:3264
  v_mfma_f32_16x16x32_bf16 v[44:47], v[72:75], v[84:87], v[44:47]
  ds_read_b64_tr_b16 v[138:139], v12 offset:3272
  v_mfma_f32_16x16x32_bf16 v[24:27], v[48:51], v[88:91], v[24:27]
  ds_read_b64_tr_b16 v[140:141], v12 offset:3776
  v_mfma_f32_16x16x32_bf16 v[28:31], v[52:55], v[88:91], v[28:31]
  ds_read_b64_tr_b16 v[142:143], v12 offset:3784
  v_mfma_f32_16x16x32_bf16 v[32:35], v[56:59], v[88:91], v[32:35]
  ds_read_b128 v[148:151], v13 offset:3264
  v_mfma_f32_16x16x32_bf16 v[36:39], v[60:63], v[88:91], v[36:39]
  ds_read_b128 v[152:155], v13 offset:2752
  v_mfma_f32_16x16x32_bf16 v[40:43], v[64:67], v[88:91], v[40:43]
  ds_read_b128 v[156:159], v13 offset:2240
  v_mfma_f32_16x16x32_bf16 v[44:47], v[68:71], v[88:91], v[44:47]
  ds_read_b128 v[160:163], v13 offset:1728
  v_mfma_f32_16x16x32_bf16 v[28:31], v[48:51], v[92:95], v[28:31]
  ds_read_b128 v[164:167], v13 offset:1216
  v_mfma_f32_16x16x32_bf16 v[32:35], v[52:55], v[92:95], v[32:35]
  ds_read_b128 v[168:171], v13 offset:704
  v_mfma_f32_16x16x32_bf16 v[36:39], v[56:59], v[92:95], v[36:39]
  ds_read_b128 v[172:175], v13 offset:192
  v_mfma_f32_16x16x32_bf16 v[40:43], v[60:63], v[92:95], v[40:43]
  v_mfma_f32_16x16x32_bf16 v[44:47], v[64:67], v[92:95], v[44:47]
  v_mfma_f32_16x16x32_bf16 v[32:35], v[48:51], v[96:99], v[32:35]
  v_mfma_f32_16x16x32_bf16 v[36:39], v[52:55], v[96:99], v[36:39]
  v_mfma_f32_16x16x32_bf16 v[40:43], v[56:59], v[96:99], v[40:43]
  v_mfma_f32_16x16x32_bf16 v[44:47], v[60:63], v[96:99], v[44:47]
  v_mfma_f32_16x16x32_bf16 v[36:39], v[48:51], v[100:103], v[36:39]
  v_mfma_f32_16x16x32_bf16 v[40:43], v[52:55], v[100:103], v[40:43]
  v_mfma_f32_16x16x32_bf16 v[44:47], v[56:59], v[100:103], v[44:47]
  v_mfma_f32_16x16x32_bf16 v[40:43], v[48:51], v[104:107], v[40:43]
  v_mfma_f32_16x16x32_bf16 v[44:47], v[52:55], v[104:107], v[44:47]
  v_mfma_f32_16x16x32_bf16 v[44:47], v[48:51], v[108:111], v[44:47]
  s_cmp_lg_u32 s40, 0
  s_cbranch_scc1 KE_cst_ok
  v_mov_b32 v10, 4
  s_waitcnt vmcnt(0)
  v_cmp_gt_u32 vcc, v10, v255
  s_nop 4
  s_cmp_eq_u64 vcc, 0
  s_cbranch_scc1 KE_cst_ok
  s_waitcnt vmcnt(0)
  v_cmp_gt_u32 vcc, v10, v251
  s_nop 4
  s_cmp_eq_u64 vcc, 0
  s_cbranch_scc1 KE_cst_ok
  s_mov_b32 s62, 20185088
  s_mov_b32 s63, 65536
KE_cst_l:
  buffer_load_dword v255, v252, s[28:31], s62 offen sc1
  s_waitcnt vmcnt(0)
  v_cmp_gt_u32 vcc, v10, v255
  s_nop 4
  s_cmp_eq_u64 vcc, 0
  s_cbranch_scc1 KE_cst_g
  s_sleep 3
  s_sub_u32 s63, s63, 1
  s_cmp_lg_u32 s63, 0
  s_cbranch_scc1 KE_cst_l
KE_cst_g:
KE_cst_ok:
  s_barrier
  s_lshl_b32 s47, s40, 12
  s_add_u32 m0, s47, 42496
  s_add_u32 s48, s47, 4194304
  buffer_load_dwordx4 v4, s[28:31], s48 offen offset:0 sc1 lds
  buffer_load_dwordx4 v4, s[28:31], s48 offen offset:1024 sc1 lds
  buffer_load_dwordx4 v4, s[28:31], s48 offen offset:2048 sc1 lds
  buffer_load_dwordx4 v4, s[28:31], s48 offen offset:3072 sc1 lds
  s_cmp_eq_u32 s40, 0
  s_cbranch_scc1 KB_now2
  v_lshrrev_b32 v10, 5, v2
  v_bfe_u32 v11, v2, 2, 2
  v_lshl_add_u32 v11, v10, 2, v11
  v_lshlrev_b32 v11, 6, v11
  v_bfe_u32 v10, v2, 4, 1
  v_lshl_add_u32 v11, v10, 5, v11
  v_and_b32 v10, 3, v2
  v_lshl_add_u32 v11, v10, 3, v11
  s_sub_u32 s69, s40, 1
  s_mul_i32 s47, s69, 3072
  s_add_u32 s47, s47, 100864
  v_add_u32 v11, s47, v11
  s_and_b32 s68, s2, 1
  s_mul_i32 s68, s68, 7
  s_add_u32 s68, s68, s69
  s_mul_i32 s68, s68, 114688
  s_lshr_b32 s67, s2, 1
  s_lshl_b32 s67, s67, 10
  s_add_u32 s68, s68, s67
  s_add_u32 s68, s68, 9437184
  s_waitcnt vmcnt(4)
  ds_read_b64_tr_b16 v[192:193], v11 offset:0
  ds_read_b64_tr_b16 v[194:195], v11 offset:512
  ds_read_b64_tr_b16 v[196:197], v11 offset:1024
  ds_read_b64_tr_b16 v[198:199], v11 offset:1536
  ds_read_b64_tr_b16 v[200:201], v11 offset:2048
  ds_read_b64_tr_b16 v[202:203], v11 offset:2560
  s_waitcnt lgkmcnt(4)
  buffer_store_dwordx4 v[192:195], v4, s[28:31], s68 offen sc1
  s_add_u32 s68, s68, 344064
  s_waitcnt lgkmcnt(2)
  buffer_store_dwordx4 v[196:199], v4, s[28:31], s68 offen sc1
  s_cmp_lg_u32 s40, 1
  s_cbranch_scc1 KB_now2
  s_add_u32 s68, s68, 344064
  s_waitcnt lgkmcnt(0)
  buffer_store_dwordx4 v[200:203], v4, s[28:31], s68 offen sc1
KB_now2:
  s_waitcnt lgkmcnt(0)
  s_waitcnt lgkmcnt(0)
  v_mfma_f32_16x16x32_bf16 v[16:19], v[112:115], v[144:147], v[16:19]
  v_mfma_f32_16x16x32_bf16 v[20:23], v[116:119], v[144:147], v[20:23]
  v_mfma_f32_16x16x32_bf16 v[24:27], v[120:123], v[144:147], v[24:27]
  v_mfma_f32_16x16x32_bf16 v[28:31], v[124:127], v[144:147], v[28:31]
  v_mfma_f32_16x16x32_bf16 v[32:35], v[128:131], v[144:147], v[32:35]
  v_mfma_f32_16x16x32_bf16 v[36:39], v[132:135], v[144:147], v[36:39]
  v_mfma_f32_16x16x32_bf16 v[40:43], v[136:139], v[144:147], v[40:43]
  v_mfma_f32_16x16x32_bf16 v[44:47], v[140:143], v[144:147], v[44:47]
  v_mfma_f32_16x16x32_bf16 v[20:23], v[112:115], v[148:151], v[20:23]
  v_mfma_f32_16x16x32_bf16 v[24:27], v[116:119], v[148:151], v[24:27]
  v_mfma_f32_16x16x32_bf16 v[28:31], v[120:123], v[148:151], v[28:31]
  v_mfma_f32_16x16x32_bf16 v[32:35], v[124:127], v[148:151], v[32:35]
  v_mfma_f32_16x16x32_bf16 v[36:39], v[128:131], v[148:151], v[36:39]
  v_mfma_f32_16x16x32_bf16 v[40:43], v[132:135], v[148:151], v[40:43]
  v_mfma_f32_16x16x32_bf16 v[44:47], v[136:139], v[148:151], v[44:47]
  v_mfma_f32_16x16x32_bf16 v[24:27], v[112:115], v[152:155], v[24:27]
  v_mfma_f32_16x16x32_bf16 v[28:31], v[116:119], v[152:155], v[28:31]
  v_mfma_f32_16x16x32_bf16 v[32:35], v[120:123], v[152:155], v[32:35]
  v_mfma_f32_16x16x32_bf16 v[36:39], v[124:127], v[152:155], v[36:39]
  v_mfma_f32_16x16x32_bf16 v[40:43], v[128:131], v[152:155], v[40:43]
  v_mfma_f32_16x16x32_bf16 v[44:47], v[132:135], v[152:155], v[44:47]
  v_mfma_f32_16x16x32_bf16 v[28:31], v[112:115], v[156:159], v[28:31]
  v_mfma_f32_16x16x32_bf16 v[32:35], v[116:119], v[156:159], v[32:35]
  v_mfma_f32_16x16x32_bf16 v[36:39], v[120:123], v[156:159], v[36:39]
  v_mfma_f32_16x16x32_bf16 v[40:43], v[124:127], v[156:159], v[40:43]
  v_mfma_f32_16x16x32_bf16 v[44:47], v[128:131], v[156:159], v[44:47]
  v_mfma_f32_16x16x32_bf16 v[32:35], v[112:115], v[160:163], v[32:35]
  v_mfma_f32_16x16x32_bf16 v[36:39], v[116:119], v[160:163], v[36:39]
  v_mfma_f32_16x16x32_bf16 v[40:43], v[120:123], v[160:163], v[40:43]
  v_mfma_f32_16x16x32_bf16 v[44:47], v[124:127], v[160:163], v[44:47]
  v_mfma_f32_16x16x32_bf16 v[36:39], v[112:115], v[164:167], v[36:39]
  v_mfma_f32_16x16x32_bf16 v[40:43], v[116:119], v[164:167], v[40:43]
  v_mfma_f32_16x16x32_bf16 v[44:47], v[120:123], v[164:167], v[44:47]
  v_mfma_f32_16x16x32_bf16 v[40:43], v[112:115], v[168:171], v[40:43]
  v_mfma_f32_16x16x32_bf16 v[44:47], v[116:119], v[168:171], v[44:47]
  v_mfma_f32_16x16x32_bf16 v[44:47], v[112:115], v[172:175], v[44:47]
  s_nop 7
  s_cmp_eq_u32 s42, 0
  s_cbranch_scc0 KC_h1
  ds_write_b128 v189, v[24:27] offset:0
  ds_write_b128 v189, v[28:31] offset:1024
  ds_write_b128 v189, v[40:43] offset:8192
  ds_write_b128 v189, v[44:47] offset:9216
  s_branch KC_hj
KC_h1:
  ds_write_b128 v189, v[16:19] offset:0
  ds_write_b128 v189, v[20:23] offset:1024
  ds_write_b128 v189, v[32:35] offset:8192
  ds_write_b128 v189, v[36:39] offset:9216
  s_nop 1
  v_mov_b32 v16, v24
  v_mov_b32 v17, v25
  v_mov_b32 v18, v26
  v_mov_b32 v19, v27
  v_mov_b32 v20, v28
  v_mov_b32 v21, v29
  v_mov_b32 v22, v30
  v_mov_b32 v23, v31
  v_mov_b32 v32, v40
  v_mov_b32 v33, v41
  v_mov_b32 v34, v42
  v_mov_b32 v35, v43
  v_mov_b32 v36, v44
  v_mov_b32 v37, v45
  v_mov_b32 v38, v46
  v_mov_b32 v39, v47
KC_hj:
  s_waitcnt vmcnt(0) lgkmcnt(0)
  s_barrier
  v_lshlrev_b32 v184, 16, v184
  ds_read_b128 v[212:215], v190 offset:0
  ds_read_b128 v[216:219], v190 offset:1024
  ds_read_b64 v[192:193], v14 offset:2560
  ds_read_b128 v[196:199], v15 offset:0
  ds_read_b128 v[204:207], v15 offset:8192
  ds_read_b64 v[194:195], v14 offset:2048
  ds_read_b128 v[200:203], v15 offset:1024
  ds_read_b128 v[208:211], v15 offset:9216
  ds_read_b128 v[68:71], v190 offset:8192
  ds_read_b128 v[72:75], v190 offset:9216
  ds_read_b64 v[48:49], v14 offset:512
  ds_read_b128 v[52:55], v15 offset:4096
  ds_read_b128 v[60:63], v15 offset:12288
  ds_read_b64 v[50:51], v14 offset:0
  ds_read_b128 v[56:59], v15 offset:5120
  ds_read_b128 v[64:67], v15 offset:13312
  s_waitcnt vmcnt(4)
  s_waitcnt lgkmcnt(8)
  v_lshlrev_b32 v220, 16, v176
  v_and_b32 v221, 0xffff0000, v176
  v_lshlrev_b32 v222, 16, v177
  v_and_b32 v223, 0xffff0000, v177
  v_lshlrev_b32 v232, 16, v178
  v_and_b32 v233, 0xffff0000, v178
  v_lshlrev_b32 v234, 16, v179
  v_and_b32 v235, 0xffff0000, v179
  s_waitcnt lgkmcnt(3)
  v_and_b32 v224, 0xffff0000, v193
  v_lshlrev_b32 v225, 16, v193
  v_and_b32 v226, 0xffff0000, v192
  v_lshlrev_b32 v227, 16, v192
  v_add_f32 v16, v16, v212
  v_add_f32 v17, v17, v213
  v_add_f32 v18, v18, v214
  v_add_f32 v19, v19, v215
  v_fma_f32 v228, v220, v196, v204
  v_fma_f32 v229, v221, v197, v205
  v_fma_f32 v230, v222, v198, v206
  v_fma_f32 v231, v223, v199, v207
  v_fma_f32 v16, v224, v184, v16
  v_fma_f32 v17, v225, v184, v17
  v_fma_f32 v18, v226, v184, v18
  v_fma_f32 v19, v227, v184, v19
  v_fma_f32 v16, v228, v16, v220
  v_fma_f32 v17, v229, v17, v221
  v_fma_f32 v18, v230, v18, v222
  v_fma_f32 v19, v231, v19, v223
  v_cvt_pk_bf16_f32 v244, v16, v17
  v_cvt_pk_bf16_f32 v245, v18, v19
  s_add_u32 s47, s50, 0
  buffer_store_dwordx2 v[244:245], v8, s[28:31], s47 offen sc1
  s_waitcnt lgkmcnt(0)
  v_and_b32 v236, 0xffff0000, v195
  v_lshlrev_b32 v237, 16, v195
  v_and_b32 v238, 0xffff0000, v194
  v_lshlrev_b32 v239, 16, v194
  v_add_f32 v20, v20, v216
  v_add_f32 v21, v21, v217
  v_add_f32 v22, v22, v218
  v_add_f32 v23, v23, v219
  v_fma_f32 v240, v232, v200, v208
  v_fma_f32 v241, v233, v201, v209
  v_fma_f32 v242, v234, v202, v210
  v_fma_f32 v243, v235, v203, v211
  v_fma_f32 v20, v236, v184, v20
  v_fma_f32 v21, v237, v184, v21
  v_fma_f32 v22, v238, v184, v22
  v_fma_f32 v23, v239, v184, v23
  v_fma_f32 v20, v240, v20, v232
  v_fma_f32 v21, v241, v21, v233
  v_fma_f32 v22, v242, v22, v234
  v_fma_f32 v23, v243, v23, v235
  v_cvt_pk_bf16_f32 v246, v20, v21
  v_cvt_pk_bf16_f32 v247, v22, v23
  s_add_u32 s47, s50, 229376
  buffer_store_dwordx2 v[246:247], v8, s[28:31], s47 offen sc1
  s_waitcnt lgkmcnt(0)
  v_lshlrev_b32 v76, 16, v180
  v_and_b32 v77, 0xffff0000, v180
  v_lshlrev_b32 v78, 16, v181
  v_and_b32 v79, 0xffff0000, v181
  v_lshlrev_b32 v88, 16, v182
  v_and_b32 v89, 0xffff0000, v182
  v_lshlrev_b32 v90, 16, v183
  v_and_b32 v91, 0xffff0000, v183
  s_waitcnt lgkmcnt(3)
  v_and_b32 v80, 0xffff0000, v49
  v_lshlrev_b32 v81, 16, v49
  v_and_b32 v82, 0xffff0000, v48
  v_lshlrev_b32 v83, 16, v48
  v_add_f32 v32, v32, v68
  v_add_f32 v33, v33, v69
  v_add_f32 v34, v34, v70
  v_add_f32 v35, v35, v71
  v_fma_f32 v84, v76, v52, v60
  v_fma_f32 v85, v77, v53, v61
  v_fma_f32 v86, v78, v54, v62
  v_fma_f32 v87, v79, v55, v63
  v_fma_f32 v32, v80, v184, v32
  v_fma_f32 v33, v81, v184, v33
  v_fma_f32 v34, v82, v184, v34
  v_fma_f32 v35, v83, v184, v35
  v_fma_f32 v32, v84, v32, v76
  v_fma_f32 v33, v85, v33, v77
  v_fma_f32 v34, v86, v34, v78
  v_fma_f32 v35, v87, v35, v79
  v_cvt_pk_bf16_f32 v244, v32, v33
  v_cvt_pk_bf16_f32 v245, v34, v35
  s_add_u32 s47, s50, 917504
  buffer_store_dwordx2 v[244:245], v8, s[28:31], s47 offen sc1
  s_waitcnt lgkmcnt(0)
  v_and_b32 v92, 0xffff0000, v51
  v_lshlrev_b32 v93, 16, v51
  v_and_b32 v94, 0xffff0000, v50
  v_lshlrev_b32 v95, 16, v50
  v_add_f32 v36, v36, v72
  v_add_f32 v37, v37, v73
  v_add_f32 v38, v38, v74
  v_add_f32 v39, v39, v75
  v_fma_f32 v96, v88, v56, v64
  v_fma_f32 v97, v89, v57, v65
  v_fma_f32 v98, v90, v58, v66
  v_fma_f32 v99, v91, v59, v67
  v_fma_f32 v36, v92, v184, v36
  v_fma_f32 v37, v93, v184, v37
  v_fma_f32 v38, v94, v184, v38
  v_fma_f32 v39, v95, v184, v39
  v_fma_f32 v36, v96, v36, v88
  v_fma_f32 v37, v97, v37, v89
  v_fma_f32 v38, v98, v38, v90
  v_fma_f32 v39, v99, v39, v91
  v_cvt_pk_bf16_f32 v246, v36, v37
  v_cvt_pk_bf16_f32 v247, v38, v39
  s_add_u32 s47, s50, 1146880
  buffer_store_dwordx2 v[246:247], v8, s[28:31], s47 offen sc1
  s_waitcnt vmcnt(0)
  s_barrier
  s_cmp_lg_u32 s40, 0
  s_cbranch_scc1 KB_aHB
  s_and_b32 s62, s2, 63
  s_lshl_b32 s62, s62, 8
  s_add_u32 s62, s62, 20201472
  s_mov_b64 exec, 1
  v_mov_b32 v10, 0
  v_mov_b32 v11, 1
  buffer_atomic_add v11, v10, s[28:31], s62 offen sc1
  s_mov_b64 exec, -1
KB_aHB:
  s_cmp_lg_u32 s40, 0
  s_cbranch_scc1 KB_cw1_ok
  v_mov_b32 v10, 7
  s_waitcnt vmcnt(8)
  v_cmp_gt_u32 vcc, v10, v254
  s_nop 4
  s_cmp_eq_u64 vcc, 0
  s_cbranch_scc1 KB_cw1_ok
  s_mov_b32 s62, 20267008
  s_mov_b32 s63, 65536
KB_cw1_l:
  buffer_load_dword v254, v253, s[28:31], s62 offen sc1
  s_waitcnt vmcnt(0)
  v_cmp_gt_u32 vcc, v10, v254
  s_nop 4
  s_cmp_eq_u64 vcc, 0
  s_cbranch_scc1 KB_cw1_g
  s_sleep 3
  s_sub_u32 s63, s63, 1
  s_cmp_lg_u32 s63, 0
  s_cbranch_scc1 KB_cw1_l
KB_cw1_g:
KB_cw1_ok:
  s_barrier
  s_add_u32 s53, s52, 0
  buffer_load_dwordx4 a[0:3], v4, s[28:31], s53 offen offset:0 sc1
  buffer_load_dwordx4 a[4:7], v4, s[28:31], s53 offen offset:1024 sc1
  buffer_load_dwordx4 a[8:11], v4, s[28:31], s53 offen offset:2048 sc1
  buffer_load_dwordx4 a[12:15], v4, s[28:31], s53 offen offset:3072 sc1
  s_add_u32 s53, s52, 4096
  buffer_load_dwordx4 a[16:19], v4, s[28:31], s53 offen offset:0 sc1
  buffer_load_dwordx4 a[20:23], v4, s[28:31], s53 offen offset:1024 sc1
  buffer_load_dwordx4 a[24:27], v4, s[28:31], s53 offen offset:2048 sc1
  buffer_load_dwordx4 a[28:31], v4, s[28:31], s53 offen offset:3072 sc1
  s_add_u32 s53, s52, 8192
  buffer_load_dwordx4 a[32:35], v4, s[28:31], s53 offen offset:0 sc1
  buffer_load_dwordx4 a[36:39], v4, s[28:31], s53 offen offset:1024 sc1
  buffer_load_dwordx4 a[40:43], v4, s[28:31], s53 offen offset:2048 sc1
  buffer_load_dwordx4 a[44:47], v4, s[28:31], s53 offen offset:3072 sc1
  s_add_u32 s53, s52, 12288
  buffer_load_dwordx4 a[48:51], v4, s[28:31], s53 offen offset:0 sc1
  buffer_load_dwordx4 a[52:55], v4, s[28:31], s53 offen offset:1024 sc1
  buffer_load_dwordx4 a[56:59], v4, s[28:31], s53 offen offset:2048 sc1
  buffer_load_dwordx4 a[60:63], v4, s[28:31], s53 offen offset:3072 sc1
  s_add_u32 s53, s52, 16384
  buffer_load_dwordx4 a[64:67], v4, s[28:31], s53 offen offset:0 sc1
  buffer_load_dwordx4 a[68:71], v4, s[28:31], s53 offen offset:1024 sc1
  buffer_load_dwordx4 a[72:75], v4, s[28:31], s53 offen offset:2048 sc1
  buffer_load_dwordx4 a[76:79], v4, s[28:31], s53 offen offset:3072 sc1
  s_add_u32 s53, s52, 20480
  buffer_load_dwordx4 a[80:83], v4, s[28:31], s53 offen offset:0 sc1
  buffer_load_dwordx4 a[84:87], v4, s[28:31], s53 offen offset:1024 sc1
  buffer_load_dwordx4 a[88:91], v4, s[28:31], s53 offen offset:2048 sc1
  buffer_load_dwordx4 a[92:95], v4, s[28:31], s53 offen offset:3072 sc1
  s_add_u32 s53, s52, 24576
  buffer_load_dwordx4 a[96:99], v4, s[28:31], s53 offen offset:0 sc1
  buffer_load_dwordx4 a[100:103], v4, s[28:31], s53 offen offset:1024 sc1
  buffer_load_dwordx4 a[104:107], v4, s[28:31], s53 offen offset:2048 sc1
  buffer_load_dwordx4 a[108:111], v4, s[28:31], s53 offen offset:3072 sc1
  s_and_b32 s41, s40, 1
  s_lshr_b32 s42, s40, 1
  s_lshl_b32 s47, s56, 1
  s_add_u32 s47, s47, s41
  s_mul_i32 s47, s47, 28672
  s_add_u32 s47, s47, 5242880
  s_mul_i32 s48, s41, 28672
  s_lshl_b32 s43, s42, 12
  s_lshl_b32 s46, s42, 11
  v_lshrrev_b32 v5, 5, v2
  v_bfe_u32 v6, v2, 2, 2
  v_lshl_add_u32 v6, v5, 3, v6
  v_lshlrev_b32 v6, 6, v6
  v_bfe_u32 v7, v2, 4, 1
  v_lshl_add_u32 v6, v7, 5, v6
  v_and_b32 v7, 3, v2
  v_lshl_add_u32 v7, v7, 3, v6
  v_add_u32 v6, 75264, v7
  s_cmp_lg_u32 s40, 0
  s_cbranch_scc1 KC_wh
  s_mov_b32 s62, 20201472
  v_cmp_gt_u32 vcc, 32, v2
  s_nop 1
  v_cndmask_b32_e64 v10, 3, 4, vcc
  s_mov_b32 s63, 65536
  s_sleep 2
  buffer_load_dword v255, v252, s[28:31], s62 offen sc1
KC_ph_l:
  s_sleep 4
  buffer_load_dword v254, v252, s[28:31], s62 offen sc1
  s_waitcnt vmcnt(1)
  v_cmp_gt_u32 vcc, v10, v255
  s_nop 4
  s_cmp_eq_u64 vcc, 0
  s_cbranch_scc1 KC_ph_g
  s_sleep 4
  buffer_load_dword v255, v252, s[28:31], s62 offen sc1
  s_waitcnt vmcnt(1)
  v_cmp_gt_u32 vcc, v10, v254
  s_nop 4
  s_cmp_eq_u64 vcc, 0
  s_cbranch_scc1 KC_ph_g
  s_sub_u32 s63, s63, 1
  s_cmp_lg_u32 s63, 0
  s_cbranch_scc1 KC_ph_l
KC_ph_g:
KC_wh:
  s_barrier
  s_add_u32 s49, s48, 75264
  s_add_u32 m0, s49, s43
  s_add_u32 s51, s47, 0
  s_add_u32 s51, s51, s43
  buffer_load_dwordx4 v4, s[28:31], s51 offen offset:0 sc1 lds
  buffer_load_dwordx4 v4, s[28:31], s51 offen offset:1024 sc1 lds
  buffer_load_dwordx4 v4, s[28:31], s51 offen offset:2048 sc1 lds
  buffer_load_dwordx4 v4, s[28:31], s51 offen offset:3072 sc1 lds
  s_add_u32 s49, s48, 83456
  s_add_u32 m0, s49, s43
  s_add_u32 s51, s47, 8192
  s_add_u32 s51, s51, s43
  buffer_load_dwordx4 v4, s[28:31], s51 offen offset:0 sc1 lds
  buffer_load_dwordx4 v4, s[28:31], s51 offen offset:1024 sc1 lds
  buffer_load_dwordx4 v4, s[28:31], s51 offen offset:2048 sc1 lds
  buffer_load_dwordx4 v4, s[28:31], s51 offen offset:3072 sc1 lds
  s_mul_i32 s53, s56, 229376
  s_lshl_b32 s54, s57, 13
  s_add_u32 s53, s53, s54
  s_lshl_b32 s54, s40, 11
  s_add_u32 s53, s53, s54
  s_add_u32 s53, s53, 12582912
  s_cmp_lt_u32 s40, 2
  s_cselect_b32 s55, 75264, 0
  s_add_u32 s55, s55, s48
  s_lshl_b32 s54, s57, 11
  s_add_u32 s55, s55, s54
  v_add_u32 v8, s55, v7
  v_and_b32 v9, 31, v2
  v_lshlrev_b32 v9, 3, v9
  s_lshl_b32 s55, s56, 1
  s_add_u32 s55, s55, s41
  s_lshl_b32 s54, s42, 5
  s_add_u32 s55, s55, s54
  s_lshl_b32 s55, s55, 8
  s_lshl_b32 s54, s57, 14
  s_add_u32 s55, s55, s54
  s_add_u32 s55, s55, 11534336
  s_mov_b32 s45, 0x3f803f80
  buffer_load_dwordx4 a[112:115], v4, s[28:31], s60 offen offset:0 sc1
  buffer_load_dwordx4 a[116:119], v4, s[28:31], s61 offen offset:0 sc1
  buffer_load_dwordx4 a[120:123], v4, s[28:31], s60 offen offset:1024 sc1
  buffer_load_dwordx4 a[124:127], v4, s[28:31], s61 offen offset:1024 sc1
  buffer_load_dwordx4 a[128:131], v4, s[28:31], s60 offen offset:2048 sc1
  buffer_load_dwordx4 a[132:135], v4, s[28:31], s61 offen offset:2048 sc1
  buffer_load_dwordx4 a[136:139], v4, s[28:31], s60 offen offset:3072 sc1
  buffer_load_dwordx4 a[140:143], v4, s[28:31], s61 offen offset:3072 sc1
  s_waitcnt vmcnt(12)
  s_barrier
KB_aHB_mark:
  ds_read_b64_tr_b16 v[192:193], v6 offset:0
  ds_read_b64_tr_b16 v[194:195], v6 offset:256
  ds_read_b64_tr_b16 v[196:197], v6 offset:28672
  ds_read_b64_tr_b16 v[198:199], v6 offset:28928
  ds_read_b64_tr_b16 v[200:201], v6 offset:1024
  ds_read_b64_tr_b16 v[202:203], v6 offset:1280
  ds_read_b64_tr_b16 v[204:205], v6 offset:29696
  ds_read_b64_tr_b16 v[206:207], v6 offset:29952
  ds_read_b64_tr_b16 v[208:209], v6 offset:2048
  ds_read_b64_tr_b16 v[210:211], v6 offset:2304
  ds_read_b64_tr_b16 v[212:213], v6 offset:30720
  ds_read_b64_tr_b16 v[214:215], v6 offset:30976
  ds_read_b64_tr_b16 v[216:217], v6 offset:3072
  ds_read_b64_tr_b16 v[218:219], v6 offset:3328
  s_waitcnt lgkmcnt(12)
  v_mfma_f32_32x32x16_bf16 v[128:143], a[0:3], v[192:195], 0
  s_add_u32 s49, s48, 91648
  s_add_u32 m0, s49, s43
  s_add_u32 s51, s47, 16384
  s_add_u32 s51, s51, s43
  buffer_load_dwordx4 v4, s[28:31], s51 offen offset:0 sc1 lds
  ds_read_b64_tr_b16 v[220:221], v6 offset:31744
  ds_read_b64_tr_b16 v[222:223], v6 offset:32000
  s_waitcnt lgkmcnt(12)
  v_mfma_f32_32x32x16_bf16 v[144:159], a[0:3], v[196:199], 0
  ds_read_b64_tr_b16 v[192:193], v6 offset:4096
  ds_read_b64_tr_b16 v[194:195], v6 offset:4352
  s_waitcnt lgkmcnt(12)
  v_mfma_f32_32x32x16_bf16 v[128:143], a[4:7], v[200:203], v[128:143]
  buffer_load_dwordx4 v4, s[28:31], s51 offen offset:1024 sc1 lds
  ds_read_b64_tr_b16 v[196:197], v6 offset:32768
  ds_read_b64_tr_b16 v[198:199], v6 offset:33024
  s_waitcnt lgkmcnt(12)
  v_mfma_f32_32x32x16_bf16 v[144:159], a[4:7], v[204:207], v[144:159]
  ds_read_b64_tr_b16 v[200:201], v6 offset:5120
  ds_read_b64_tr_b16 v[202:203], v6 offset:5376
  s_waitcnt lgkmcnt(12)
  v_mfma_f32_32x32x16_bf16 v[128:143], a[8:11], v[208:211], v[128:143]
  buffer_load_dwordx4 v4, s[28:31], s51 offen offset:2048 sc1 lds
  ds_read_b64_tr_b16 v[204:205], v6 offset:33792
  ds_read_b64_tr_b16 v[206:207], v6 offset:34048
  s_waitcnt lgkmcnt(12)
  v_mfma_f32_32x32x16_bf16 v[144:159], a[8:11], v[212:215], v[144:159]
  ds_read_b64_tr_b16 v[208:209], v6 offset:6144
  ds_read_b64_tr_b16 v[210:211], v6 offset:6400
  s_waitcnt lgkmcnt(12)
  v_mfma_f32_32x32x16_bf16 v[128:143], a[12:15], v[216:219], v[128:143]
  buffer_load_dwordx4 v4, s[28:31], s51 offen offset:3072 sc1 lds
  ds_read_b64_tr_b16 v[212:213], v6 offset:34816
  ds_read_b64_tr_b16 v[214:215], v6 offset:35072
  s_waitcnt lgkmcnt(12)
  v_mfma_f32_32x32x16_bf16 v[144:159], a[12:15], v[220:223], v[144:159]
  s_waitcnt vmcnt(12)
  s_barrier
  ds_read_b64_tr_b16 v[216:217], v6 offset:7168
  ds_read_b64_tr_b16 v[218:219], v6 offset:7424
  s_waitcnt lgkmcnt(12)
  v_mfma_f32_32x32x16_bf16 v[128:143], a[16:19], v[192:195], v[128:143]
  s_add_u32 s49, s48, 99840
  s_add_u32 m0, s49, s46
  s_add_u32 s51, s47, 24576
  s_add_u32 s51, s51, s46
  buffer_load_dwordx4 v4, s[28:31], s51 offen offset:0 sc1 lds
  ds_read_b64_tr_b16 v[220:221], v6 offset:35840
  ds_read_b64_tr_b16 v[222:223], v6 offset:36096
  s_waitcnt lgkmcnt(12)
  v_mfma_f32_32x32x16_bf16 v[144:159], a[16:19], v[196:199], v[144:159]
  ds_read_b64_tr_b16 v[192:193], v6 offset:8192
  ds_read_b64_tr_b16 v[194:195], v6 offset:8448
  s_waitcnt lgkmcnt(12)
  v_mfma_f32_32x32x16_bf16 v[128:143], a[20:23], v[200:203], v[128:143]
  buffer_load_dwordx4 v4, s[28:31], s51 offen offset:1024 sc1 lds
  ds_read_b64_tr_b16 v[196:197], v6 offset:36864
  ds_read_b64_tr_b16 v[198:199], v6 offset:37120
  s_waitcnt lgkmcnt(12)
  v_mfma_f32_32x32x16_bf16 v[144:159], a[20:23], v[204:207], v[144:159]
  ds_read_b64_tr_b16 v[200:201], v6 offset:9216
  ds_read_b64_tr_b16 v[202:203], v6 offset:9472
  s_waitcnt lgkmcnt(12)
  v_mfma_f32_32x32x16_bf16 v[128:143], a[24:27], v[208:211], v[128:143]
  ds_read_b64_tr_b16 v[204:205], v6 offset:37888
  ds_read_b64_tr_b16 v[206:207], v6 offset:38144
  s_waitcnt lgkmcnt(12)
  v_mfma_f32_32x32x16_bf16 v[144:159], a[24:27], v[212:215], v[144:159]
  s_add_u32 s60, s60, 4096
  buffer_load_dwordx4 a[144:147], v4, s[28:31], s60 offen offset:0 sc1
  ds_read_b64_tr_b16 v[208:209], v6 offset:10240
  ds_read_b64_tr_b16 v[210:211], v6 offset:10496
  s_waitcnt lgkmcnt(12)
  v_mfma_f32_32x32x16_bf16 v[128:143], a[28:31], v[216:219], v[128:143]
  ds_read_b64_tr_b16 v[212:213], v6 offset:38912
  ds_read_b64_tr_b16 v[214:215], v6 offset:39168
  s_waitcnt lgkmcnt(12)
  v_mfma_f32_32x32x16_bf16 v[144:159], a[28:31], v[220:223], v[144:159]
  s_add_u32 s61, s61, 4096
  buffer_load_dwordx4 a[148:151], v4, s[28:31], s61 offen offset:0 sc1
  ds_read_b64_tr_b16 v[216:217], v6 offset:11264
  ds_read_b64_tr_b16 v[218:219], v6 offset:11520
  s_waitcnt lgkmcnt(12)
  v_mfma_f32_32x32x16_bf16 v[128:143], a[32:35], v[192:195], v[128:143]
  ds_read_b64_tr_b16 v[220:221], v6 offset:39936
  ds_read_b64_tr_b16 v[222:223], v6 offset:40192
  s_waitcnt lgkmcnt(12)
  v_mfma_f32_32x32x16_bf16 v[144:159], a[32:35], v[196:199], v[144:159]
  buffer_load_dwordx4 a[152:155], v4, s[28:31], s60 offen offset:1024 sc1
  ds_read_b64_tr_b16 v[192:193], v6 offset:12288
  ds_read_b64_tr_b16 v[194:195], v6 offset:12544
  s_waitcnt lgkmcnt(12)
  v_mfma_f32_32x32x16_bf16 v[128:143], a[36:39], v[200:203], v[128:143]
  ds_read_b64_tr_b16 v[196:197], v6 offset:40960
  ds_read_b64_tr_b16 v[198:199], v6 offset:41216
  s_waitcnt lgkmcnt(12)
  v_mfma_f32_32x32x16_bf16 v[144:159], a[36:39], v[204:207], v[144:159]
  buffer_load_dwordx4 a[156:159], v4, s[28:31], s61 offen offset:1024 sc1
  ds_read_b64_tr_b16 v[200:201], v6 offset:13312
  ds_read_b64_tr_b16 v[202:203], v6 offset:13568
  s_waitcnt lgkmcnt(12)
  v_mfma_f32_32x32x16_bf16 v[128:143], a[40:43], v[208:211], v[128:143]
  ds_read_b64_tr_b16 v[204:205], v6 offset:41984
  ds_read_b64_tr_b16 v[206:207], v6 offset:42240
  s_waitcnt lgkmcnt(12)
  v_mfma_f32_32x32x16_bf16 v[144:159], a[40:43], v[212:215], v[144:159]
  buffer_load_dwordx4 a[160:163], v4, s[28:31], s60 offen offset:2048 sc1
  ds_read_b64_tr_b16 v[208:209], v6 offset:14336
  ds_read_b64_tr_b16 v[210:211], v6 offset:14592
  s_waitcnt lgkmcnt(12)
  v_mfma_f32_32x32x16_bf16 v[128:143], a[44:47], v[216:219], v[128:143]
  ds_read_b64_tr_b16 v[212:213], v6 offset:43008
  ds_read_b64_tr_b16 v[214:215], v6 offset:43264
  s_waitcnt lgkmcnt(12)
  v_mfma_f32_32x32x16_bf16 v[144:159], a[44:47], v[220:223], v[144:159]
  buffer_load_dwordx4 a[164:167], v4, s[28:31], s61 offen offset:2048 sc1
  s_waitcnt vmcnt(8)
  s_barrier
  ds_read_b64_tr_b16 v[216:217], v6 offset:15360
  ds_read_b64_tr_b16 v[218:219], v6 offset:15616
  s_waitcnt lgkmcnt(12)
  v_mfma_f32_32x32x16_bf16 v[128:143], a[48:51], v[192:195], v[128:143]
  ds_read_b64_tr_b16 v[220:221], v6 offset:44032
  ds_read_b64_tr_b16 v[222:223], v6 offset:44288
  s_waitcnt lgkmcnt(12)
  v_mfma_f32_32x32x16_bf16 v[144:159], a[48:51], v[196:199], v[144:159]
  buffer_load_dwordx4 a[168:171], v4, s[28:31], s60 offen offset:3072 sc1
  ds_read_b64_tr_b16 v[192:193], v6 offset:16384
  ds_read_b64_tr_b16 v[194:195], v6 offset:16640
  s_waitcnt lgkmcnt(12)
  v_mfma_f32_32x32x16_bf16 v[128:143], a[52:55], v[200:203], v[128:143]
  ds_read_b64_tr_b16 v[196:197], v6 offset:45056
  ds_read_b64_tr_b16 v[198:199], v6 offset:45312
  s_waitcnt lgkmcnt(12)
  v_mfma_f32_32x32x16_bf16 v[144:159], a[52:55], v[204:207], v[144:159]
  buffer_load_dwordx4 a[172:175], v4, s[28:31], s61 offen offset:3072 sc1
  ds_read_b64_tr_b16 v[200:201], v6 offset:17408
  ds_read_b64_tr_b16 v[202:203], v6 offset:17664
  s_waitcnt lgkmcnt(12)
  v_mfma_f32_32x32x16_bf16 v[128:143], a[56:59], v[208:211], v[128:143]
  s_add_u32 s49, s48, 0
  s_add_u32 m0, s49, s43
  s_add_u32 s51, s47, 917504
  s_add_u32 s51, s51, s43
  buffer_load_dwordx4 v4, s[28:31], s51 offen offset:0 sc1 lds
  ds_read_b64_tr_b16 v[204:205], v6 offset:46080
  ds_read_b64_tr_b16 v[206:207], v6 offset:46336
  s_waitcnt lgkmcnt(12)
  v_mfma_f32_32x32x16_bf16 v[144:159], a[56:59], v[212:215], v[144:159]
  ds_read_b64_tr_b16 v[208:209], v6 offset:18432
  ds_read_b64_tr_b16 v[210:211], v6 offset:18688
  s_waitcnt lgkmcnt(12)
  v_mfma_f32_32x32x16_bf16 v[128:143], a[60:63], v[216:219], v[128:143]
  buffer_load_dwordx4 v4, s[28:31], s51 offen offset:1024 sc1 lds
  ds_read_b64_tr_b16 v[212:213], v6 offset:47104
  ds_read_b64_tr_b16 v[214:215], v6 offset:47360
  s_waitcnt lgkmcnt(12)
  v_mfma_f32_32x32x16_bf16 v[144:159], a[60:63], v[220:223], v[144:159]
  ds_read_b64_tr_b16 v[216:217], v6 offset:19456
  ds_read_b64_tr_b16 v[218:219], v6 offset:19712
  s_waitcnt lgkmcnt(12)
  v_mfma_f32_32x32x16_bf16 v[128:143], a[64:67], v[192:195], v[128:143]
  buffer_load_dwordx4 v4, s[28:31], s51 offen offset:2048 sc1 lds
  ds_read_b64_tr_b16 v[220:221], v6 offset:48128
  ds_read_b64_tr_b16 v[222:223], v6 offset:48384
  s_waitcnt lgkmcnt(12)
  v_mfma_f32_32x32x16_bf16 v[144:159], a[64:67], v[196:199], v[144:159]
  ds_read_b64_tr_b16 v[192:193], v6 offset:20480
  ds_read_b64_tr_b16 v[194:195], v6 offset:20736
  s_waitcnt lgkmcnt(12)
  v_mfma_f32_32x32x16_bf16 v[128:143], a[68:71], v[200:203], v[128:143]
  buffer_load_dwordx4 v4, s[28:31], s51 offen offset:3072 sc1 lds
  ds_read_b64_tr_b16 v[196:197], v6 offset:49152
  ds_read_b64_tr_b16 v[198:199], v6 offset:49408
  s_waitcnt lgkmcnt(12)
  v_mfma_f32_32x32x16_bf16 v[144:159], a[68:71], v[204:207], v[144:159]
  ds_read_b64_tr_b16 v[200:201], v6 offset:21504
  ds_read_b64_tr_b16 v[202:203], v6 offset:21760
  s_waitcnt lgkmcnt(12)
  v_mfma_f32_32x32x16_bf16 v[128:143], a[72:75], v[208:211], v[128:143]
  s_add_u32 s49, s48, 8192
  s_add_u32 m0, s49, s43
  s_add_u32 s51, s47, 925696
  s_add_u32 s51, s51, s43
  buffer_load_dwordx4 v4, s[28:31], s51 offen offset:0 sc1 lds
  ds_read_b64_tr_b16 v[204:205], v6 offset:50176
  ds_read_b64_tr_b16 v[206:207], v6 offset:50432
  s_waitcnt lgkmcnt(12)
  v_mfma_f32_32x32x16_bf16 v[144:159], a[72:75], v[212:215], v[144:159]
  ds_read_b64_tr_b16 v[208:209], v6 offset:22528
  ds_read_b64_tr_b16 v[210:211], v6 offset:22784
  s_waitcnt lgkmcnt(12)
  v_mfma_f32_32x32x16_bf16 v[128:143], a[76:79], v[216:219], v[128:143]
  buffer_load_dwordx4 v4, s[28:31], s51 offen offset:1024 sc1 lds
  ds_read_b64_tr_b16 v[212:213], v6 offset:51200
  ds_read_b64_tr_b16 v[214:215], v6 offset:51456
  s_waitcnt lgkmcnt(12)
  v_mfma_f32_32x32x16_bf16 v[144:159], a[76:79], v[220:223], v[144:159]
  s_waitcnt vmcnt(14)
  s_barrier
  ds_read_b64_tr_b16 v[216:217], v6 offset:23552
  ds_read_b64_tr_b16 v[218:219], v6 offset:23808
  s_waitcnt lgkmcnt(12)
  v_mfma_f32_32x32x16_bf16 v[128:143], a[80:83], v[192:195], v[128:143]
  buffer_load_dwordx4 v4, s[28:31], s51 offen offset:2048 sc1 lds
  ds_read_b64_tr_b16 v[220:221], v6 offset:52224
  ds_read_b64_tr_b16 v[222:223], v6 offset:52480
  s_waitcnt lgkmcnt(12)
  v_mfma_f32_32x32x16_bf16 v[144:159], a[80:83], v[196:199], v[144:159]
  ds_read_b64_tr_b16 v[192:193], v6 offset:24576
  ds_read_b64_tr_b16 v[194:195], v6 offset:24832
  s_waitcnt lgkmcnt(12)
  v_mfma_f32_32x32x16_bf16 v[128:143], a[84:87], v[200:203], v[128:143]
  buffer_load_dwordx4 v4, s[28:31], s51 offen offset:3072 sc1 lds
  ds_read_b64_tr_b16 v[196:197], v6 offset:25600
  ds_read_b64_tr_b16 v[198:199], v6 offset:25856
  s_waitcnt lgkmcnt(12)
  v_mfma_f32_32x32x16_bf16 v[144:159], a[84:87], v[204:207], v[144:159]
  ds_read_b64_tr_b16 v[200:201], v6 offset:26624
  ds_read_b64_tr_b16 v[202:203], v6 offset:26880
  s_waitcnt lgkmcnt(12)
  v_mfma_f32_32x32x16_bf16 v[128:143], a[88:91], v[208:211], v[128:143]
  s_add_u32 s49, s48, 16384
  s_add_u32 m0, s49, s43
  s_add_u32 s51, s47, 933888
  s_add_u32 s51, s51, s43
  buffer_load_dwordx4 v4, s[28:31], s51 offen offset:0 sc1 lds
  ds_read_b64_tr_b16 v[204:205], v6 offset:27648
  ds_read_b64_tr_b16 v[206:207], v6 offset:27904
  s_waitcnt lgkmcnt(12)
  v_mfma_f32_32x32x16_bf16 v[144:159], a[88:91], v[212:215], v[144:159]
  ds_read_b64_tr_b16 v[208:209], v6 offset:53248
  ds_read_b64_tr_b16 v[210:211], v6 offset:53504
  s_waitcnt lgkmcnt(12)
  v_mfma_f32_32x32x16_bf16 v[128:143], a[92:95], v[216:219], v[128:143]
  buffer_load_dwordx4 v4, s[28:31], s51 offen offset:1024 sc1 lds
  ds_read_b64_tr_b16 v[212:213], v6 offset:54272
  ds_read_b64_tr_b16 v[214:215], v6 offset:54528
  s_waitcnt lgkmcnt(12)
  v_mfma_f32_32x32x16_bf16 v[144:159], a[92:95], v[220:223], v[144:159]
  ds_read_b64_tr_b16 v[216:217], v6 offset:55296
  ds_read_b64_tr_b16 v[218:219], v6 offset:55552
  s_waitcnt lgkmcnt(12)
  v_mfma_f32_32x32x16_bf16 v[128:143], a[96:99], v[192:195], v[128:143]
  buffer_load_dwordx4 v4, s[28:31], s51 offen offset:2048 sc1 lds
  ds_read_b64_tr_b16 v[220:221], v6 offset:56320
  ds_read_b64_tr_b16 v[222:223], v6 offset:56576
  s_waitcnt lgkmcnt(12)
  v_mfma_f32_32x32x16_bf16 v[128:143], a[100:103], v[196:199], v[128:143]
  s_waitcnt vmcnt(7)
  s_barrier
  ds_read_b64_tr_b16 v[192:193], v7 offset:0
  ds_read_b64_tr_b16 v[194:195], v7 offset:256
  s_waitcnt lgkmcnt(12)
  v_mfma_f32_32x32x16_bf16 v[128:143], a[104:107], v[200:203], v[128:143]
  buffer_load_dwordx4 v4, s[28:31], s51 offen offset:3072 sc1 lds
  ds_read_b64_tr_b16 v[196:197], v7 offset:28672
  ds_read_b64_tr_b16 v[198:199], v7 offset:28928
  s_waitcnt lgkmcnt(12)
  v_mfma_f32_32x32x16_bf16 v[128:143], a[108:111], v[204:207], v[128:143]
  ds_read_b64_tr_b16 v[200:201], v7 offset:1024
  ds_read_b64_tr_b16 v[202:203], v7 offset:1280
  s_waitcnt lgkmcnt(12)
  v_mfma_f32_32x32x16_bf16 v[144:159], a[96:99], v[208:211], v[144:159]
  s_add_u32 s49, s48, 24576
  s_add_u32 m0, s49, s46
  s_add_u32 s51, s47, 942080
  s_add_u32 s51, s51, s46
  buffer_load_dwordx4 v4, s[28:31], s51 offen offset:0 sc1 lds
  ds_read_b64_tr_b16 v[204:205], v7 offset:29696
  ds_read_b64_tr_b16 v[206:207], v7 offset:29952
  s_waitcnt lgkmcnt(12)
  v_mfma_f32_32x32x16_bf16 v[144:159], a[100:103], v[212:215], v[144:159]
  ds_read_b64_tr_b16 v[208:209], v7 offset:2048
  ds_read_b64_tr_b16 v[210:211], v7 offset:2304
  s_waitcnt lgkmcnt(12)
  v_mfma_f32_32x32x16_bf16 v[144:159], a[104:107], v[216:219], v[144:159]
  buffer_load_dwordx4 v4, s[28:31], s51 offen offset:1024 sc1 lds
  ds_read_b64_tr_b16 v[212:213], v7 offset:30720
  ds_read_b64_tr_b16 v[214:215], v7 offset:30976
  s_waitcnt lgkmcnt(12)
  v_mfma_f32_32x32x16_bf16 v[144:159], a[108:111], v[220:223], v[144:159]
  ds_read_b64_tr_b16 v[216:217], v7 offset:3072
  ds_read_b64_tr_b16 v[218:219], v7 offset:3328
  s_waitcnt lgkmcnt(12)
  v_mfma_f32_32x32x16_bf16 v[160:175], a[0:3], v[192:195], 0
  ds_read_b64_tr_b16 v[220:221], v7 offset:31744
  ds_read_b64_tr_b16 v[222:223], v7 offset:32000
  s_waitcnt lgkmcnt(12)
  v_mfma_f32_32x32x16_bf16 v[176:191], a[0:3], v[196:199], 0
  v_cvt_pk_bf16_f32 v224, v128, v129
  v_cvt_pk_bf16_f32 v225, v130, v131
  v_cvt_pk_bf16_f32 v226, v132, v133
  v_cvt_pk_bf16_f32 v227, v134, v135
  v_cvt_pk_bf16_f32 v228, v136, v137
  ds_read_b64_tr_b16 v[192:193], v7 offset:4096
  ds_read_b64_tr_b16 v[194:195], v7 offset:4352
  s_waitcnt lgkmcnt(12)
  v_mfma_f32_32x32x16_bf16 v[160:175], a[4:7], v[200:203], v[160:175]
  s_add_u32 s60, s60, 4096
  buffer_load_dwordx4 a[176:179], v4, s[28:31], s60 offen offset:0 sc1
  v_cvt_pk_bf16_f32 v229, v138, v139
  v_cvt_pk_bf16_f32 v230, v140, v141
  v_cvt_pk_bf16_f32 v231, v142, v143
  v_pk_max_i16 v224, v224, 0
  v_pk_max_i16 v225, v225, 0
  ds_read_b64_tr_b16 v[196:197], v7 offset:32768
  ds_read_b64_tr_b16 v[198:199], v7 offset:33024
  s_waitcnt lgkmcnt(12)
  v_mfma_f32_32x32x16_bf16 v[176:191], a[4:7], v[204:207], v[176:191]
  v_pk_max_i16 v226, v226, 0
  v_pk_max_i16 v227, v227, 0
  v_pk_max_i16 v228, v228, 0
  v_pk_max_i16 v229, v229, 0
  v_pk_max_i16 v230, v230, 0
  ds_read_b64_tr_b16 v[200:201], v7 offset:5120
  ds_read_b64_tr_b16 v[202:203], v7 offset:5376
  s_waitcnt lgkmcnt(12)
  v_mfma_f32_32x32x16_bf16 v[160:175], a[8:11], v[208:211], v[160:175]
  s_add_u32 s61, s61, 4096
  buffer_load_dwordx4 a[180:183], v4, s[28:31], s61 offen offset:0 sc1
  v_pk_max_i16 v231, v231, 0
  s_add_u32 s54, s53, 0
  buffer_store_dwordx4 v[224:227], v4, s[28:31], s54 offen sc1
  buffer_store_dwordx4 v[228:231], v4, s[28:31], s54 offen offset:1024 sc1
  ds_read_b64_tr_b16 v[204:205], v7 offset:33792
  ds_read_b64_tr_b16 v[206:207], v7 offset:34048
  s_waitcnt lgkmcnt(12)
  v_mfma_f32_32x32x16_bf16 v[176:191], a[8:11], v[212:215], v[176:191]
  ds_read_b64_tr_b16 v[208:209], v7 offset:6144
  ds_read_b64_tr_b16 v[210:211], v7 offset:6400
  s_waitcnt lgkmcnt(12)
  v_mfma_f32_32x32x16_bf16 v[160:175], a[12:15], v[216:219], v[160:175]
  buffer_load_dwordx4 a[184:187], v4, s[28:31], s60 offen offset:1024 sc1
  v_cvt_pk_bf16_f32 v232, v144, v145
  v_cvt_pk_bf16_f32 v233, v146, v147
  v_cvt_pk_bf16_f32 v234, v148, v149
  v_cvt_pk_bf16_f32 v235, v150, v151
  v_cvt_pk_bf16_f32 v236, v152, v153
  ds_read_b64_tr_b16 v[212:213], v7 offset:34816
  ds_read_b64_tr_b16 v[214:215], v7 offset:35072
  s_waitcnt lgkmcnt(12)
  v_mfma_f32_32x32x16_bf16 v[176:191], a[12:15], v[220:223], v[176:191]
  v_cvt_pk_bf16_f32 v237, v154, v155
  v_cvt_pk_bf16_f32 v238, v156, v157
  v_cvt_pk_bf16_f32 v239, v158, v159
  v_pk_max_i16 v232, v232, 0
  v_pk_max_i16 v233, v233, 0
  s_waitcnt vmcnt(11)
  s_barrier
  ds_read_b64_tr_b16 v[216:217], v7 offset:7168
  ds_read_b64_tr_b16 v[218:219], v7 offset:7424
  s_waitcnt lgkmcnt(12)
  v_mfma_f32_32x32x16_bf16 v[160:175], a[16:19], v[192:195], v[160:175]
  buffer_load_dwordx4 a[188:191], v4, s[28:31], s61 offen offset:1024 sc1
  v_pk_max_i16 v234, v234, 0
  v_pk_max_i16 v235, v235, 0
  v_pk_max_i16 v236, v236, 0
  v_pk_max_i16 v237, v237, 0
  v_pk_max_i16 v238, v238, 0
  ds_read_b64_tr_b16 v[220:221], v7 offset:35840
  ds_read_b64_tr_b16 v[222:223], v7 offset:36096
  s_waitcnt lgkmcnt(12)
  v_mfma_f32_32x32x16_bf16 v[176:191], a[16:19], v[196:199], v[176:191]
  v_pk_max_i16 v239, v239, 0
  s_add_u32 s54, s53, 114688
  buffer_store_dwordx4 v[232:235], v4, s[28:31], s54 offen sc1
  buffer_store_dwordx4 v[236:239], v4, s[28:31], s54 offen offset:1024 sc1
  ds_read_b64_tr_b16 v[192:193], v7 offset:8192
  ds_read_b64_tr_b16 v[194:195], v7 offset:8448
  s_waitcnt lgkmcnt(12)
  v_mfma_f32_32x32x16_bf16 v[160:175], a[20:23], v[200:203], v[160:175]
  buffer_load_dwordx4 a[192:195], v4, s[28:31], s60 offen offset:2048 sc1
  ds_read_b64_tr_b16 v[196:197], v7 offset:36864
  ds_read_b64_tr_b16 v[198:199], v7 offset:37120
  s_waitcnt lgkmcnt(12)
  v_mfma_f32_32x32x16_bf16 v[176:191], a[20:23], v[204:207], v[176:191]
  ds_read_b64_tr_b16 v[200:201], v7 offset:9216
  ds_read_b64_tr_b16 v[202:203], v7 offset:9472
  s_waitcnt lgkmcnt(12)
  v_mfma_f32_32x32x16_bf16 v[160:175], a[24:27], v[208:211], v[160:175]
  buffer_load_dwordx4 a[196:199], v4, s[28:31], s61 offen offset:2048 sc1
  ds_read_b64_tr_b16 v[204:205], v7 offset:37888
  ds_read_b64_tr_b16 v[206:207], v7 offset:38144
  s_waitcnt lgkmcnt(12)
  v_mfma_f32_32x32x16_bf16 v[176:191], a[24:27], v[212:215], v[176:191]
  ds_read_b64_tr_b16 v[208:209], v7 offset:10240
  ds_read_b64_tr_b16 v[210:211], v7 offset:10496
  s_waitcnt lgkmcnt(12)
  v_mfma_f32_32x32x16_bf16 v[160:175], a[28:31], v[216:219], v[160:175]
  buffer_load_dwordx4 a[200:203], v4, s[28:31], s60 offen offset:3072 sc1
  ds_read_b64_tr_b16 v[212:213], v7 offset:38912
  ds_read_b64_tr_b16 v[214:215], v7 offset:39168
  s_waitcnt lgkmcnt(12)
  v_mfma_f32_32x32x16_bf16 v[176:191], a[28:31], v[220:223], v[176:191]
  ds_read_b64_tr_b16 v[216:217], v7 offset:11264
  ds_read_b64_tr_b16 v[218:219], v7 offset:11520
  s_waitcnt lgkmcnt(12)
  v_mfma_f32_32x32x16_bf16 v[160:175], a[32:35], v[192:195], v[160:175]
  buffer_load_dwordx4 a[204:207], v4, s[28:31], s61 offen offset:3072 sc1
  ds_read_b64_tr_b16 v[220:221], v7 offset:39936
  ds_read_b64_tr_b16 v[222:223], v7 offset:40192
  s_waitcnt lgkmcnt(12)
  v_mfma_f32_32x32x16_bf16 v[176:191], a[32:35], v[196:199], v[176:191]
  ds_read_b64_tr_b16 v[192:193], v7 offset:12288
  ds_read_b64_tr_b16 v[194:195], v7 offset:12544
  s_waitcnt lgkmcnt(12)
  v_mfma_f32_32x32x16_bf16 v[160:175], a[36:39], v[200:203], v[160:175]
  s_add_u32 s60, s60, 4096
  buffer_load_dwordx4 a[208:211], v4, s[28:31], s60 offen offset:0 sc1
  ds_read_b64_tr_b16 v[196:197], v7 offset:40960
  ds_read_b64_tr_b16 v[198:199], v7 offset:41216
  s_waitcnt lgkmcnt(12)
  v_mfma_f32_32x32x16_bf16 v[176:191], a[36:39], v[204:207], v[176:191]
  ds_read_b64_tr_b16 v[200:201], v7 offset:13312
  ds_read_b64_tr_b16 v[202:203], v7 offset:13568
  s_waitcnt lgkmcnt(12)
  v_mfma_f32_32x32x16_bf16 v[160:175], a[40:43], v[208:211], v[160:175]
  s_add_u32 s61, s61, 4096
  buffer_load_dwordx4 a[212:215], v4, s[28:31], s61 offen offset:0 sc1
  ds_read_b64_tr_b16 v[204:205], v7 offset:41984
  ds_read_b64_tr_b16 v[206:207], v7 offset:42240
  s_waitcnt lgkmcnt(12)
  v_mfma_f32_32x32x16_bf16 v[176:191], a[40:43], v[212:215], v[176:191]
  ds_read_b64_tr_b16 v[208:209], v7 offset:14336
  ds_read_b64_tr_b16 v[210:211], v7 offset:14592
  s_waitcnt lgkmcnt(12)
  v_mfma_f32_32x32x16_bf16 v[160:175], a[44:47], v[216:219], v[160:175]
  buffer_load_dwordx4 a[216:219], v4, s[28:31], s60 offen offset:1024 sc1
  ds_read_b64_tr_b16 v[212:213], v7 offset:43008
  ds_read_b64_tr_b16 v[214:215], v7 offset:43264
  s_waitcnt lgkmcnt(12)
  v_mfma_f32_32x32x16_bf16 v[176:191], a[44:47], v[220:223], v[176:191]
  s_waitcnt vmcnt(17)
  s_barrier
  ds_read_b64_tr_b16 v[216:217], v7 offset:15360
  ds_read_b64_tr_b16 v[218:219], v7 offset:15616
  s_waitcnt lgkmcnt(12)
  v_mfma_f32_32x32x16_bf16 v[160:175], a[48:51], v[192:195], v[160:175]
  buffer_load_dwordx4 a[220:223], v4, s[28:31], s61 offen offset:1024 sc1
  ds_read_b64_tr_b16 v[220:221], v7 offset:44032
  ds_read_b64_tr_b16 v[222:223], v7 offset:44288
  s_waitcnt lgkmcnt(12)
  v_mfma_f32_32x32x16_bf16 v[176:191], a[48:51], v[196:199], v[176:191]
  ds_read_b64_tr_b16 v[192:193], v7 offset:16384
  ds_read_b64_tr_b16 v[194:195], v7 offset:16640
  s_waitcnt lgkmcnt(12)
  v_mfma_f32_32x32x16_bf16 v[160:175], a[52:55], v[200:203], v[160:175]
  buffer_load_dwordx4 a[224:227], v4, s[28:31], s60 offen offset:2048 sc1
  ds_read_b64_tr_b16 v[196:197], v7 offset:45056
  ds_read_b64_tr_b16 v[198:199], v7 offset:45312
  s_waitcnt lgkmcnt(12)
  v_mfma_f32_32x32x16_bf16 v[176:191], a[52:55], v[204:207], v[176:191]
  ds_read_b64_tr_b16 v[200:201], v7 offset:17408
  ds_read_b64_tr_b16 v[202:203], v7 offset:17664
  s_waitcnt lgkmcnt(12)
  v_mfma_f32_32x32x16_bf16 v[160:175], a[56:59], v[208:211], v[160:175]
  buffer_load_dwordx4 a[228:231], v4, s[28:31], s61 offen offset:2048 sc1
  ds_read_b64_tr_b16 v[204:205], v7 offset:46080
  ds_read_b64_tr_b16 v[206:207], v7 offset:46336
  s_waitcnt lgkmcnt(12)
  v_mfma_f32_32x32x16_bf16 v[176:191], a[56:59], v[212:215], v[176:191]
  ds_read_b64_tr_b16 v[208:209], v7 offset:18432
  ds_read_b64_tr_b16 v[210:211], v7 offset:18688
  s_waitcnt lgkmcnt(12)
  v_mfma_f32_32x32x16_bf16 v[160:175], a[60:63], v[216:219], v[160:175]
  buffer_load_dwordx4 a[232:235], v4, s[28:31], s60 offen offset:3072 sc1
  ds_read_b64_tr_b16 v[212:213], v7 offset:47104
  ds_read_b64_tr_b16 v[214:215], v7 offset:47360
  s_waitcnt lgkmcnt(12)
  v_mfma_f32_32x32x16_bf16 v[176:191], a[60:63], v[220:223], v[176:191]
  s_waitcnt vmcnt(11)
  s_barrier
  s_cmp_lg_u32 s40, 0
  s_cbranch_scc1 KB_aGA
  s_lshl_b32 s62, s56, 2
  s_and_b32 s63, s57, 3
  s_add_u32 s62, s62, s63
  s_lshl_b32 s62, s62, 8
  s_add_u32 s62, s62, 20234240
  s_mov_b64 exec, 1
  v_mov_b32 v10, 0
  v_mov_b32 v11, 1
  buffer_atomic_add v11, v10, s[28:31], s62 offen sc1
  s_mov_b64 exec, -1
KB_aGA:
  ds_read_b64_tr_b16 v[216:217], v7 offset:19456
  ds_read_b64_tr_b16 v[218:219], v7 offset:19712
  s_waitcnt lgkmcnt(12)
  v_mfma_f32_32x32x16_bf16 v[160:175], a[64:67], v[192:195], v[160:175]
  buffer_load_dwordx4 a[236:239], v4, s[28:31], s61 offen offset:3072 sc1
  ds_read_b64_tr_b16 v[220:221], v7 offset:48128
  ds_read_b64_tr_b16 v[222:223], v7 offset:48384
  s_waitcnt lgkmcnt(12)
  v_mfma_f32_32x32x16_bf16 v[176:191], a[64:67], v[196:199], v[176:191]
  ds_read_b64_tr_b16 v[192:193], v7 offset:20480
  ds_read_b64_tr_b16 v[194:195], v7 offset:20736
  s_waitcnt lgkmcnt(12)
  v_mfma_f32_32x32x16_bf16 v[160:175], a[68:71], v[200:203], v[160:175]
  s_add_u32 s60, s60, 4096
  buffer_load_dwordx4 a[240:243], v4, s[28:31], s60 offen offset:0 sc1
  ds_read_b64_tr_b16 v[196:197], v7 offset:49152
  ds_read_b64_tr_b16 v[198:199], v7 offset:49408
  s_waitcnt lgkmcnt(12)
  v_mfma_f32_32x32x16_bf16 v[176:191], a[68:71], v[204:207], v[176:191]
  ds_read_b64_tr_b16 v[200:201], v7 offset:21504
  ds_read_b64_tr_b16 v[202:203], v7 offset:21760
  s_waitcnt lgkmcnt(12)
  v_mfma_f32_32x32x16_bf16 v[160:175], a[72:75], v[208:211], v[160:175]
  s_add_u32 s61, s61, 4096
  buffer_load_dwordx4 a[244:247], v4, s[28:31], s61 offen offset:0 sc1
  ds_read_b64_tr_b16 v[204:205], v7 offset:50176
  ds_read_b64_tr_b16 v[206:207], v7 offset:50432
  s_waitcnt lgkmcnt(12)
  v_mfma_f32_32x32x16_bf16 v[176:191], a[72:75], v[212:215], v[176:191]
  ds_read_b64_tr_b16 v[208:209], v7 offset:22528
  ds_read_b64_tr_b16 v[210:211], v7 offset:22784
  s_waitcnt lgkmcnt(12)
  v_mfma_f32_32x32x16_bf16 v[160:175], a[76:79], v[216:219], v[160:175]
  buffer_load_dwordx4 a[248:251], v4, s[28:31], s60 offen offset:1024 sc1
  ds_read_b64_tr_b16 v[212:213], v7 offset:51200
  ds_read_b64_tr_b16 v[214:215], v7 offset:51456
  s_waitcnt lgkmcnt(12)
  v_mfma_f32_32x32x16_bf16 v[176:191], a[76:79], v[220:223], v[176:191]
  s_waitcnt vmcnt(23)
  s_barrier
  ds_read_b64_tr_b16 v[216:217], v7 offset:23552
  ds_read_b64_tr_b16 v[218:219], v7 offset:23808
  s_waitcnt lgkmcnt(12)
  v_mfma_f32_32x32x16_bf16 v[160:175], a[80:83], v[192:195], v[160:175]
  buffer_load_dwordx4 a[252:255], v4, s[28:31], s61 offen offset:1024 sc1
  ds_read_b64_tr_b16 v[220:221], v7 offset:52224
  ds_read_b64_tr_b16 v[222:223], v7 offset:52480
  s_waitcnt lgkmcnt(12)
  v_mfma_f32_32x32x16_bf16 v[176:191], a[80:83], v[196:199], v[176:191]
  ds_read_b64_tr_b16 v[240:241], v8 offset:0
  ds_read_b64_tr_b16 v[242:243], v8 offset:256
  ds_read_b64_tr_b16 v[192:193], v7 offset:24576
  ds_read_b64_tr_b16 v[194:195], v7 offset:24832
  s_waitcnt lgkmcnt(12)
  v_mfma_f32_32x32x16_bf16 v[160:175], a[84:87], v[200:203], v[160:175]
  buffer_load_dwordx4 a[0:3], v4, s[28:31], s60 offen offset:2048 sc1
  ds_read_b64_tr_b16 v[244:245], v8 offset:1024
  ds_read_b64_tr_b16 v[246:247], v8 offset:1280
  ds_read_b64_tr_b16 v[196:197], v7 offset:25600
  ds_read_b64_tr_b16 v[198:199], v7 offset:25856
  s_waitcnt lgkmcnt(12)
  v_mfma_f32_32x32x16_bf16 v[176:191], a[84:87], v[204:207], v[176:191]
  v_mov_b32 v248, 0
  v_mov_b32 v249, 0
  ds_read_b64_tr_b16 v[200:201], v7 offset:26624
  ds_read_b64_tr_b16 v[202:203], v7 offset:26880
  s_waitcnt lgkmcnt(12)
  v_mfma_f32_32x32x16_bf16 v[160:175], a[88:91], v[208:211], v[160:175]
  buffer_load_dwordx4 a[4:7], v4, s[28:31], s61 offen offset:2048 sc1
  ds_read_b64_tr_b16 v[204:205], v7 offset:27648
  ds_read_b64_tr_b16 v[206:207], v7 offset:27904
  s_waitcnt lgkmcnt(12)
  v_mfma_f32_32x32x16_bf16 v[176:191], a[88:91], v[212:215], v[176:191]
  ds_read_b64_tr_b16 v[208:209], v7 offset:53248
  ds_read_b64_tr_b16 v[210:211], v7 offset:53504
  s_waitcnt lgkmcnt(12)
  v_mfma_f32_32x32x16_bf16 v[160:175], a[92:95], v[216:219], v[160:175]
  buffer_load_dwordx4 a[8:11], v4, s[28:31], s60 offen offset:3072 sc1
  s_cmp_lg_u32 s40, 0
  s_cbranch_scc1 KB_iga_i
  s_lshr_b32 s62, s58, 1
  s_lshl_b32 s62, s62, 10
  s_add_u32 s62, s62, 20234240
  buffer_load_dword v254, v253, s[28:31], s62 offen sc1
KB_iga_i:
  ds_read_b64_tr_b16 v[212:213], v7 offset:54272
  ds_read_b64_tr_b16 v[214:215], v7 offset:54528
  s_waitcnt lgkmcnt(12)
  v_mfma_f32_32x32x16_bf16 v[176:191], a[92:95], v[220:223], v[176:191]
  ds_read_b64_tr_b16 v[216:217], v7 offset:55296
  ds_read_b64_tr_b16 v[218:219], v7 offset:55552
  s_waitcnt lgkmcnt(12)
  v_mfma_f32_32x32x16_bf16 v[160:175], a[96:99], v[192:195], v[160:175]
  buffer_load_dwordx4 a[12:15], v4, s[28:31], s61 offen offset:3072 sc1
  ds_read_b64_tr_b16 v[220:221], v7 offset:56320
  ds_read_b64_tr_b16 v[222:223], v7 offset:56576
  s_waitcnt lgkmcnt(12)
  v_mfma_f32_32x32x16_bf16 v[160:175], a[100:103], v[196:199], v[160:175]
  v_dot2_f32_bf16 v248, v240, s45, v248
  v_dot2_f32_bf16 v249, v240, v240, v249
  v_dot2_f32_bf16 v248, v241, s45, v248
  v_dot2_f32_bf16 v249, v241, v241, v249
  s_waitcnt lgkmcnt(10)
  v_mfma_f32_32x32x16_bf16 v[160:175], a[104:107], v[200:203], v[160:175]
  s_add_u32 s60, s60, 4096
  buffer_load_dwordx4 a[16:19], v4, s[28:31], s60 offen offset:0 sc1
  v_dot2_f32_bf16 v248, v242, s45, v248
  v_dot2_f32_bf16 v249, v242, v242, v249
  v_dot2_f32_bf16 v248, v243, s45, v248
  v_dot2_f32_bf16 v249, v243, v243, v249
  s_waitcnt lgkmcnt(8)
  v_mfma_f32_32x32x16_bf16 v[160:175], a[108:111], v[204:207], v[160:175]
  v_dot2_f32_bf16 v248, v244, s45, v248
  v_dot2_f32_bf16 v249, v244, v244, v249
  v_dot2_f32_bf16 v248, v245, s45, v248
  v_dot2_f32_bf16 v249, v245, v245, v249
  s_waitcnt lgkmcnt(6)
  v_mfma_f32_32x32x16_bf16 v[176:191], a[96:99], v[208:211], v[176:191]
  s_add_u32 s61, s61, 4096
  buffer_load_dwordx4 a[20:23], v4, s[28:31], s61 offen offset:0 sc1
  v_dot2_f32_bf16 v248, v246, s45, v248
  v_dot2_f32_bf16 v249, v246, v246, v249
  v_dot2_f32_bf16 v248, v247, s45, v248
  v_dot2_f32_bf16 v249, v247, v247, v249
  s_waitcnt lgkmcnt(4)
  v_mfma_f32_32x32x16_bf16 v[176:191], a[100:103], v[212:215], v[176:191]
  s_waitcnt lgkmcnt(2)
  v_mfma_f32_32x32x16_bf16 v[176:191], a[104:107], v[216:219], v[176:191]
  buffer_load_dwordx4 a[24:27], v4, s[28:31], s60 offen offset:1024 sc1
  s_waitcnt lgkmcnt(0)
  v_mfma_f32_32x32x16_bf16 v[176:191], a[108:111], v[220:223], v[176:191]
  s_cmp_lg_u32 s40, 0
  s_cbranch_scc1 KB_iga2_i
  s_lshr_b32 s62, s58, 1
  s_lshl_b32 s62, s62, 10
  s_add_u32 s62, s62, 20234240
  buffer_load_dword v255, v253, s[28:31], s62 offen sc1
KB_iga2_i:
  s_nop 1
  v_mov_b32 v250, v248
  v_mov_b32 v251, v249
  s_nop 1
  v_permlane32_swap_b32 v248, v250
  v_permlane32_swap_b32 v249, v251
  v_cvt_pk_bf16_f32 v224, v160, v161
  v_cvt_pk_bf16_f32 v225, v162, v163
  v_cvt_pk_bf16_f32 v226, v164, v165
  v_cvt_pk_bf16_f32 v227, v166, v167
  v_cvt_pk_bf16_f32 v228, v168, v169
  v_cvt_pk_bf16_f32 v229, v170, v171
  v_cvt_pk_bf16_f32 v230, v172, v173
  v_cvt_pk_bf16_f32 v231, v174, v175
  v_pk_max_i16 v224, v224, 0
  v_pk_max_i16 v225, v225, 0
  v_pk_max_i16 v226, v226, 0
  v_pk_max_i16 v227, v227, 0
  v_pk_max_i16 v228, v228, 0
  v_pk_max_i16 v229, v229, 0
  v_pk_max_i16 v230, v230, 0
  v_pk_max_i16 v231, v231, 0
  s_add_u32 s54, s53, 3670016
  buffer_store_dwordx4 v[224:227], v4, s[28:31], s54 offen sc1
  buffer_store_dwordx4 v[228:231], v4, s[28:31], s54 offen offset:1024 sc1
  v_add_f32 v248, v248, v250
  v_add_f32 v249, v249, v251
  v_cvt_pk_bf16_f32 v232, v176, v177
  v_cvt_pk_bf16_f32 v233, v178, v179
  v_cvt_pk_bf16_f32 v234, v180, v181
  v_cvt_pk_bf16_f32 v235, v182, v183
  v_cvt_pk_bf16_f32 v236, v184, v185
  v_cvt_pk_bf16_f32 v237, v186, v187
  v_cvt_pk_bf16_f32 v238, v188, v189
  v_cvt_pk_bf16_f32 v239, v190, v191
  v_pk_max_i16 v232, v232, 0
  v_pk_max_i16 v233, v233, 0
  v_pk_max_i16 v234, v234, 0
  v_pk_max_i16 v235, v235, 0
  v_pk_max_i16 v236, v236, 0
  v_pk_max_i16 v237, v237, 0
  v_pk_max_i16 v238, v238, 0
  v_pk_max_i16 v239, v239, 0
  s_add_u32 s54, s53, 3784704
  buffer_store_dwordx4 v[232:235], v4, s[28:31], s54 offen sc1
  buffer_store_dwordx4 v[236:239], v4, s[28:31], s54 offen offset:1024 sc1
  s_mov_b32 exec_hi, 0
  buffer_store_dwordx2 v[248:249], v9, s[28:31], s55 offen sc1
  s_mov_b64 exec, -1
  s_lshr_b32 s52, s40, 1
  s_and_b32 s54, s40, 1
  s_mul_i32 s48, s40, 28672
  s_mul_i32 s49, s58, 114688
  s_add_u32 s49, s49, s48
  s_add_u32 s49, s49, 16252928
  s_mul_i32 s47, s58, 114688
  s_add_u32 s47, s47, s48
  s_add_u32 s47, s47, 12582912
  s_cmp_lg_u32 s40, 0
  s_cbranch_scc1 KB_cga_ok
  v_and_b32 v10, 2, v2
  v_cmp_eq_u32 vcc, 0, v10
  s_nop 1
  v_cndmask_b32_e64 v10, 3, 4, vcc
  s_waitcnt vmcnt(9)
  v_cmp_gt_u32 vcc, v10, v254
  s_nop 4
  s_cmp_eq_u64 vcc, 0
  s_cbranch_scc1 KB_cga_ok
  s_waitcnt vmcnt(5)
  v_cmp_gt_u32 vcc, v10, v255
  s_nop 4
  s_cmp_eq_u64 vcc, 0
  s_cbranch_scc1 KB_cga_ok
  s_lshr_b32 s62, s58, 1
  s_lshl_b32 s62, s62, 10
  s_add_u32 s62, s62, 20234240
  s_mov_b32 s63, 65536
KB_cga_l:
  buffer_load_dword v254, v253, s[28:31], s62 offen sc1
  s_waitcnt vmcnt(0)
  v_cmp_gt_u32 vcc, v10, v254
  s_nop 4
  s_cmp_eq_u64 vcc, 0
  s_cbranch_scc1 KB_cga_g
  s_sleep 2
  s_sub_u32 s63, s63, 1
  s_cmp_lg_u32 s63, 0
  s_cbranch_scc1 KB_cga_l
KB_cga_g:
KB_cga_ok:
  s_barrier
  buffer_load_dwordx4 v[16:19], v4, s[28:31], s47 offen offset:0 sc1
  buffer_load_dwordx4 v[20:23], v4, s[28:31], s47 offen offset:1024 sc1
  buffer_load_dwordx4 v[24:27], v4, s[28:31], s47 offen offset:2048 sc1
  buffer_load_dwordx4 v[28:31], v4, s[28:31], s47 offen offset:3072 sc1
  s_add_u32 s47, s47, 4096
  buffer_load_dwordx4 v[32:35], v4, s[28:31], s47 offen offset:0 sc1
  buffer_load_dwordx4 v[36:39], v4, s[28:31], s47 offen offset:1024 sc1
  buffer_load_dwordx4 v[40:43], v4, s[28:31], s47 offen offset:2048 sc1
  buffer_load_dwordx4 v[44:47], v4, s[28:31], s47 offen offset:3072 sc1
  s_add_u32 s47, s47, 4096
  buffer_load_dwordx4 v[48:51], v4, s[28:31], s47 offen offset:0 sc1
  buffer_load_dwordx4 v[52:55], v4, s[28:31], s47 offen offset:1024 sc1
  buffer_load_dwordx4 v[56:59], v4, s[28:31], s47 offen offset:2048 sc1
  buffer_load_dwordx4 v[60:63], v4, s[28:31], s47 offen offset:3072 sc1
  s_add_u32 s47, s47, 4096
  buffer_load_dwordx4 v[64:67], v4, s[28:31], s47 offen offset:0 sc1
  buffer_load_dwordx4 v[68:71], v4, s[28:31], s47 offen offset:1024 sc1
  buffer_load_dwordx4 v[72:75], v4, s[28:31], s47 offen offset:2048 sc1
  s_mul_i32 s53, s58, 28672
  s_lshl_b32 s44, s59, 12
  s_add_u32 s53, s53, s44
  s_lshl_b32 s44, s54, 11
  s_add_u32 s53, s53, s44
  s_lshl_b32 s44, s52, 10
  s_add_u32 s53, s53, s44
  s_add_u32 s53, s53, 5242880
  s_lshl_b32 s55, s40, 11
  s_add_u32 s55, s55, 57344
  v_and_b32 v3, 31, v2
  v_lshlrev_b32 v6, 3, v3
  v_lshl_add_u32 v6, v5, 13, v6
  s_lshl_b32 s50, s58, 8
  s_add_u32 s50, s50, 11534336
  v_bfe_u32 v7, v2, 2, 2
  v_lshl_add_u32 v7, v5, 2, v7
  v_lshlrev_b32 v7, 6, v7
  v_bfe_u32 v8, v2, 4, 1
  v_lshl_add_u32 v7, v8, 5, v7
  v_and_b32 v8, 3, v2
  v_lshl_add_u32 v7, v8, 3, v7
  v_add_u32 v7, s55, v7
  s_lshl_b32 s44, s40, 11
  v_add_u32 v14, s44, v4
  s_lshl_b32 s44, s40, 13
  v_add_u32 v15, s44, v4
  v_mul_u32_u24 v9, 896, v3
  v_lshl_add_u32 v9, v5, 4, v9
  s_mul_i32 s48, s58, 28672
  s_lshl_b32 s44, s59, 7
  s_add_u32 s48, s48, s44
  s_lshl_b32 s44, s54, 6
  s_add_u32 s48, s48, s44
  s_lshl_b32 s44, s52, 5
  s_add_u32 s48, s48, s44
  s_mov_b32 s16, s20
  s_mov_b32 s17, s21
  s_mov_b32 s18, 1835008
  s_mov_b32 s19, 0x20000
  s_waitcnt vmcnt(14)
  v_mfma_f32_32x32x16_bf16 v[80:95], a[112:115], v[16:19], 0
  buffer_load_dwordx4 v[76:79], v4, s[28:31], s47 offen offset:3072 sc1
  v_mfma_f32_32x32x16_bf16 v[96:111], a[116:119], v[16:19], 0
  s_waitcnt vmcnt(16)
  s_barrier
  s_cmp_lg_u32 s40, 0
  s_cbranch_scc1 KB_aGB
  s_lshl_b32 s62, s56, 2
  s_and_b32 s63, s57, 3
  s_add_u32 s62, s62, s63
  s_lshl_b32 s62, s62, 8
  s_add_u32 s62, s62, 20250624
  s_mov_b64 exec, 1
  v_mov_b32 v10, 0
  v_mov_b32 v11, 1
  buffer_atomic_add v11, v10, s[28:31], s62 offen sc1
  s_mov_b64 exec, -1
KB_aGB:
  s_mov_b32 m0, s55
  s_add_u32 s44, s53, 917504
  buffer_load_dwordx4 v4, s[28:31], s53 offen sc1 lds
  s_add_u32 m0, s55, 1024
  s_nop 0
  buffer_load_dwordx4 v4, s[28:31], s44 offen sc1 lds
  s_waitcnt vmcnt(16)
  v_mfma_f32_32x32x16_bf16 v[80:95], a[120:123], v[20:23], v[80:95]
  s_add_u32 s47, s47, 4096
  buffer_load_dwordx4 v[16:19], v4, s[28:31], s47 offen offset:0 sc1
  v_mfma_f32_32x32x16_bf16 v[96:111], a[124:127], v[20:23], v[96:111]
  s_waitcnt vmcnt(16)
  v_mfma_f32_32x32x16_bf16 v[80:95], a[128:131], v[24:27], v[80:95]
  buffer_load_dwordx4 v[20:23], v4, s[28:31], s47 offen offset:1024 sc1
  v_mfma_f32_32x32x16_bf16 v[96:111], a[132:135], v[24:27], v[96:111]
  s_waitcnt vmcnt(16)
  v_mfma_f32_32x32x16_bf16 v[80:95], a[136:139], v[28:31], v[80:95]
  buffer_load_dwordx4 v[24:27], v4, s[28:31], s47 offen offset:2048 sc1
  v_mfma_f32_32x32x16_bf16 v[96:111], a[140:143], v[28:31], v[96:111]
  s_waitcnt vmcnt(16)
  v_mfma_f32_32x32x16_bf16 v[80:95], a[144:147], v[32:35], v[80:95]
  buffer_load_dwordx4 v[28:31], v4, s[28:31], s47 offen offset:3072 sc1
  v_mfma_f32_32x32x16_bf16 v[96:111], a[148:151], v[32:35], v[96:111]
  s_waitcnt vmcnt(16)
  v_mfma_f32_32x32x16_bf16 v[80:95], a[152:155], v[36:39], v[80:95]
  s_add_u32 s47, s47, 4096
  buffer_load_dwordx4 v[32:35], v4, s[28:31], s47 offen offset:0 sc1
  v_mfma_f32_32x32x16_bf16 v[96:111], a[156:159], v[36:39], v[96:111]
  s_waitcnt vmcnt(16)
  v_mfma_f32_32x32x16_bf16 v[80:95], a[160:163], v[40:43], v[80:95]
  buffer_load_dwordx4 v[36:39], v4, s[28:31], s47 offen offset:1024 sc1
  v_mfma_f32_32x32x16_bf16 v[96:111], a[164:167], v[40:43], v[96:111]
  s_waitcnt vmcnt(16)
  v_mfma_f32_32x32x16_bf16 v[80:95], a[168:171], v[44:47], v[80:95]
  buffer_load_dwordx4 v[40:43], v4, s[28:31], s47 offen offset:2048 sc1
  v_mfma_f32_32x32x16_bf16 v[96:111], a[172:175], v[44:47], v[96:111]
  buffer_load_dwordx4 a[28:31], v4, s[28:31], s61 offen offset:1024 sc1
  s_waitcnt vmcnt(17)
  v_mfma_f32_32x32x16_bf16 v[80:95], a[176:179], v[48:51], v[80:95]
  buffer_load_dwordx4 v[44:47], v4, s[28:31], s47 offen offset:3072 sc1
  v_mfma_f32_32x32x16_bf16 v[96:111], a[180:183], v[48:51], v[96:111]
  buffer_load_dwordx4 a[32:35], v4, s[28:31], s60 offen offset:2048 sc1
  s_waitcnt vmcnt(18)
  v_mfma_f32_32x32x16_bf16 v[80:95], a[184:187], v[52:55], v[80:95]
  s_add_u32 s47, s47, 4096
  buffer_load_dwordx4 v[48:51], v4, s[28:31], s47 offen offset:0 sc1
  v_mfma_f32_32x32x16_bf16 v[96:111], a[188:191], v[52:55], v[96:111]
  buffer_load_dwordx4 a[36:39], v4, s[28:31], s61 offen offset:2048 sc1
  s_waitcnt vmcnt(19)
  v_mfma_f32_32x32x16_bf16 v[80:95], a[192:195], v[56:59], v[80:95]
  buffer_load_dwordx4 v[52:55], v4, s[28:31], s47 offen offset:1024 sc1
  v_mfma_f32_32x32x16_bf16 v[96:111], a[196:199], v[56:59], v[96:111]
  buffer_load_dwordx4 a[40:43], v4, s[28:31], s60 offen offset:3072 sc1
  s_waitcnt vmcnt(20)
  v_mfma_f32_32x32x16_bf16 v[80:95], a[200:203], v[60:63], v[80:95]
  buffer_load_dwordx4 v[56:59], v4, s[28:31], s47 offen offset:2048 sc1
  v_mfma_f32_32x32x16_bf16 v[96:111], a[204:207], v[60:63], v[96:111]
  buffer_load_dwordx4 a[44:47], v4, s[28:31], s61 offen offset:3072 sc1
  s_cmp_lg_u32 s40, 0
  s_cbranch_scc1 KB_igb_i
  s_lshr_b32 s62, s58, 1
  s_lshl_b32 s62, s62, 10
  s_add_u32 s62, s62, 20250624
  buffer_load_dword v254, v253, s[28:31], s62 offen sc1
KB_igb_i:
  s_waitcnt vmcnt(21)
  v_mfma_f32_32x32x16_bf16 v[80:95], a[208:211], v[64:67], v[80:95]
  buffer_load_dwordx4 v[60:63], v4, s[28:31], s47 offen offset:3072 sc1
  v_mfma_f32_32x32x16_bf16 v[96:111], a[212:215], v[64:67], v[96:111]
  s_add_u32 s60, s60, 4096
  buffer_load_dwordx4 a[48:51], v4, s[28:31], s60 offen offset:0 sc1
  s_waitcnt vmcnt(22)
  v_mfma_f32_32x32x16_bf16 v[80:95], a[216:219], v[68:71], v[80:95]
  s_add_u32 s61, s61, 4096
  buffer_load_dwordx4 a[52:55], v4, s[28:31], s61 offen offset:0 sc1
  v_mfma_f32_32x32x16_bf16 v[96:111], a[220:223], v[68:71], v[96:111]
  buffer_load_dwordx4 a[56:59], v4, s[28:31], s60 offen offset:1024 sc1
  s_waitcnt vmcnt(23)
  v_mfma_f32_32x32x16_bf16 v[80:95], a[224:227], v[72:75], v[80:95]
  buffer_load_dwordx4 a[60:63], v4, s[28:31], s61 offen offset:1024 sc1
  v_mfma_f32_32x32x16_bf16 v[96:111], a[228:231], v[72:75], v[96:111]
  buffer_load_dwordx4 a[64:67], v4, s[28:31], s60 offen offset:2048 sc1
  s_waitcnt vmcnt(24)
  v_mfma_f32_32x32x16_bf16 v[80:95], a[232:235], v[76:79], v[80:95]
  buffer_load_dwordx4 a[68:71], v4, s[28:31], s61 offen offset:2048 sc1
  v_mfma_f32_32x32x16_bf16 v[96:111], a[236:239], v[76:79], v[96:111]
  buffer_load_dwordx4 a[72:75], v4, s[28:31], s60 offen offset:3072 sc1
  s_cmp_lg_u32 s40, 0
  s_cbranch_scc1 KB_igb2_i
  s_lshr_b32 s62, s58, 1
  s_lshl_b32 s62, s62, 10
  s_add_u32 s62, s62, 20250624
  buffer_load_dword v255, v253, s[28:31], s62 offen sc1
KB_igb2_i:
  s_waitcnt vmcnt(23)
  v_mfma_f32_32x32x16_bf16 v[80:95], a[240:243], v[16:19], v[80:95]
  buffer_load_dwordx4 a[76:79], v4, s[28:31], s61 offen offset:3072 sc1
  v_mfma_f32_32x32x16_bf16 v[96:111], a[244:247], v[16:19], v[96:111]
  s_waitcnt vmcnt(23)
  v_mfma_f32_32x32x16_bf16 v[80:95], a[248:251], v[20:23], v[80:95]
  v_mfma_f32_32x32x16_bf16 v[96:111], a[252:255], v[20:23], v[96:111]
  s_waitcnt vmcnt(22)
  v_mfma_f32_32x32x16_bf16 v[80:95], a[0:3], v[24:27], v[80:95]
  v_mfma_f32_32x32x16_bf16 v[96:111], a[4:7], v[24:27], v[96:111]
  s_cmp_lg_u32 s40, 0
  s_cbranch_scc1 KB_cgb_ok
  v_and_b32 v10, 2, v2
  v_cmp_eq_u32 vcc, 0, v10
  s_nop 1
  v_cndmask_b32_e64 v10, 3, 4, vcc
  s_waitcnt vmcnt(9)
  v_cmp_gt_u32 vcc, v10, v254
  s_nop 4
  s_cmp_eq_u64 vcc, 0
  s_cbranch_scc1 KB_cgb_ok
  s_waitcnt vmcnt(1)
  v_cmp_gt_u32 vcc, v10, v255
  s_nop 4
  s_cmp_eq_u64 vcc, 0
  s_cbranch_scc1 KB_cgb_ok
  s_lshr_b32 s62, s58, 1
  s_lshl_b32 s62, s62, 10
  s_add_u32 s62, s62, 20250624
  s_mov_b32 s63, 65536
KB_cgb_l:
  buffer_load_dword v254, v253, s[28:31], s62 offen sc1
  s_waitcnt vmcnt(0)
  v_cmp_gt_u32 vcc, v10, v254
  s_nop 4
  s_cmp_eq_u64 vcc, 0
  s_cbranch_scc1 KB_cgb_g
  s_sleep 2
  s_sub_u32 s63, s63, 1
  s_cmp_lg_u32 s63, 0
  s_cbranch_scc1 KB_cgb_l
KB_cgb_g:
KB_cgb_ok:
  s_barrier
  s_waitcnt vmcnt(21)
  v_mfma_f32_32x32x16_bf16 v[80:95], a[8:11], v[28:31], v[80:95]
  buffer_load_dwordx4 v[64:67], v4, s[28:31], s49 offen offset:0 sc1
  v_mfma_f32_32x32x16_bf16 v[96:111], a[12:15], v[28:31], v[96:111]
  buffer_load_dwordx4 v[68:71], v4, s[28:31], s49 offen offset:1024 sc1
  s_waitcnt vmcnt(22)
  v_mfma_f32_32x32x16_bf16 v[80:95], a[16:19], v[32:35], v[80:95]
  buffer_load_dwordx4 v[72:75], v4, s[28:31], s49 offen offset:2048 sc1
  v_mfma_f32_32x32x16_bf16 v[96:111], a[20:23], v[32:35], v[96:111]
  buffer_load_dwordx4 v[76:79], v4, s[28:31], s49 offen offset:3072 sc1
  buffer_load_dwordx2 v[160:161], v6, s[28:31], s50 offen sc1
  s_add_u32 s50, s50, 16384
  buffer_load_dwordx2 v[162:163], v6, s[28:31], s50 offen sc1
  s_add_u32 s50, s50, 16384
  s_waitcnt vmcnt(23)
  v_mfma_f32_32x32x16_bf16 v[80:95], a[24:27], v[36:39], v[80:95]
  s_add_u32 s49, s49, 4096
  buffer_load_dwordx4 v[16:19], v4, s[28:31], s49 offen offset:0 sc1
  v_mfma_f32_32x32x16_bf16 v[96:111], a[28:31], v[36:39], v[96:111]
  buffer_load_dwordx4 v[20:23], v4, s[28:31], s49 offen offset:1024 sc1
  buffer_load_dwordx2 v[164:165], v6, s[28:31], s50 offen sc1
  s_add_u32 s50, s50, 16384
  buffer_load_dwordx2 v[166:167], v6, s[28:31], s50 offen sc1
  s_add_u32 s50, s50, 16384
  s_waitcnt vmcnt(23)
  v_mfma_f32_32x32x16_bf16 v[80:95], a[32:35], v[40:43], v[80:95]
  buffer_load_dwordx4 v[24:27], v4, s[28:31], s49 offen offset:2048 sc1
  v_mfma_f32_32x32x16_bf16 v[96:111], a[36:39], v[40:43], v[96:111]
  buffer_load_dwordx4 v[28:31], v4, s[28:31], s49 offen offset:3072 sc1
  buffer_load_dwordx2 v[168:169], v6, s[28:31], s50 offen sc1
  s_add_u32 s50, s50, 16384
  buffer_load_dwordx2 v[170:171], v6, s[28:31], s50 offen sc1
  s_add_u32 s50, s50, 16384
  s_waitcnt vmcnt(23)
  v_mfma_f32_32x32x16_bf16 v[80:95], a[40:43], v[44:47], v[80:95]
  s_add_u32 s49, s49, 4096
  buffer_load_dwordx4 v[32:35], v4, s[28:31], s49 offen offset:0 sc1
  v_mfma_f32_32x32x16_bf16 v[96:111], a[44:47], v[44:47], v[96:111]
  buffer_load_dwordx4 v[36:39], v4, s[28:31], s49 offen offset:1024 sc1
  buffer_load_dwordx2 v[172:173], v6, s[28:31], s50 offen sc1
  s_add_u32 s50, s50, 16384
  buffer_load_dwordx2 v[174:175], v6, s[28:31], s50 offen sc1
  s_add_u32 s50, s50, 16384
  s_waitcnt vmcnt(24)
  v_mfma_f32_32x32x16_bf16 v[80:95], a[48:51], v[48:51], v[80:95]
  buffer_load_dwordx4 v[40:43], v4, s[28:31], s49 offen offset:2048 sc1
  v_mfma_f32_32x32x16_bf16 v[96:111], a[52:55], v[48:51], v[96:111]
  buffer_load_dwordx4 v[44:47], v4, s[28:31], s49 offen offset:3072 sc1
  buffer_load_dwordx2 v[176:177], v6, s[28:31], s50 offen sc1
  s_add_u32 s50, s50, 16384
  buffer_load_dwordx2 v[178:179], v6, s[28:31], s50 offen sc1
  s_add_u32 s50, s50, 16384
  s_waitcnt vmcnt(26)
  v_mfma_f32_32x32x16_bf16 v[80:95], a[56:59], v[52:55], v[80:95]
  s_add_u32 s49, s49, 4096
  buffer_load_dwordx4 v[48:51], v4, s[28:31], s49 offen offset:0 sc1
  v_mfma_f32_32x32x16_bf16 v[96:111], a[60:63], v[52:55], v[96:111]
  buffer_load_dwordx2 v[180:181], v6, s[28:31], s50 offen sc1
  s_add_u32 s50, s50, 16384
  buffer_load_dwordx2 v[182:183], v6, s[28:31], s50 offen sc1
  s_add_u32 s50, s50, 16384
  s_waitcnt vmcnt(27)
  v_mfma_f32_32x32x16_bf16 v[80:95], a[64:67], v[56:59], v[80:95]
  buffer_load_dwordx4 v[52:55], v4, s[28:31], s49 offen offset:1024 sc1
  v_mfma_f32_32x32x16_bf16 v[96:111], a[68:71], v[56:59], v[96:111]
  buffer_load_dwordx2 v[184:185], v6, s[28:31], s50 offen sc1
  s_add_u32 s50, s50, 16384
  buffer_load_dwordx2 v[186:187], v6, s[28:31], s50 offen sc1
  s_waitcnt vmcnt(28)
  v_mfma_f32_32x32x16_bf16 v[80:95], a[72:75], v[60:63], v[80:95]
  buffer_load_dwordx4 v[56:59], v4, s[28:31], s49 offen offset:2048 sc1
  v_mfma_f32_32x32x16_bf16 v[96:111], a[76:79], v[60:63], v[96:111]
  s_waitcnt vmcnt(28)
  v_mfma_f32_32x32x16_bf16 v[112:127], a[112:115], v[64:67], 0
  buffer_load_dwordx4 v[60:63], v4, s[28:31], s49 offen offset:3072 sc1
  v_mfma_f32_32x32x16_bf16 v[128:143], a[116:119], v[64:67], 0
  s_waitcnt vmcnt(28)
  v_mfma_f32_32x32x16_bf16 v[112:127], a[120:123], v[68:71], v[112:127]
  s_add_u32 s49, s49, 4096
  buffer_load_dwordx4 v[64:67], v4, s[28:31], s49 offen offset:0 sc1
  v_mfma_f32_32x32x16_bf16 v[128:143], a[124:127], v[68:71], v[128:143]
  s_waitcnt vmcnt(28)
  v_mfma_f32_32x32x16_bf16 v[112:127], a[128:131], v[72:75], v[112:127]
  buffer_load_dwordx4 v[68:71], v4, s[28:31], s49 offen offset:1024 sc1
  ds_write_b128 v14, v[80:83] offset:0
  v_mfma_f32_32x32x16_bf16 v[128:143], a[132:135], v[72:75], v[128:143]
  ds_write_b128 v14, v[84:87] offset:1024
  s_waitcnt vmcnt(28)
  v_mfma_f32_32x32x16_bf16 v[112:127], a[136:139], v[76:79], v[112:127]
  buffer_load_dwordx4 v[72:75], v4, s[28:31], s49 offen offset:2048 sc1
  ds_write_b128 v14, v[96:99] offset:8192
  v_mfma_f32_32x32x16_bf16 v[128:143], a[140:143], v[76:79], v[128:143]
  ds_write_b128 v14, v[100:103] offset:9216
  s_waitcnt vmcnt(26)
  v_mfma_f32_32x32x16_bf16 v[112:127], a[144:147], v[16:19], v[112:127]
  buffer_load_dwordx4 v[76:79], v4, s[28:31], s49 offen offset:3072 sc1
  ds_write_b128 v14, v[88:91] offset:16384
  v_mfma_f32_32x32x16_bf16 v[128:143], a[148:151], v[16:19], v[128:143]
  ds_write_b128 v14, v[92:95] offset:17408
  s_waitcnt vmcnt(26)
  v_mfma_f32_32x32x16_bf16 v[112:127], a[152:155], v[20:23], v[112:127]
  s_add_u32 s49, s49, 4096
  buffer_load_dwordx4 v[16:19], v4, s[28:31], s49 offen offset:0 sc1
  ds_write_b128 v14, v[104:107] offset:24576
  v_mfma_f32_32x32x16_bf16 v[128:143], a[156:159], v[20:23], v[128:143]
  ds_write_b128 v14, v[108:111] offset:25600
  s_waitcnt vmcnt(24)
  v_mfma_f32_32x32x16_bf16 v[112:127], a[160:163], v[24:27], v[112:127]
  buffer_load_dwordx4 v[20:23], v4, s[28:31], s49 offen offset:1024 sc1
  v_mfma_f32_32x32x16_bf16 v[128:143], a[164:167], v[24:27], v[128:143]
  s_waitcnt vmcnt(24)
  v_mfma_f32_32x32x16_bf16 v[112:127], a[168:171], v[28:31], v[112:127]
  buffer_load_dwordx4 v[24:27], v4, s[28:31], s49 offen offset:2048 sc1
  s_waitcnt lgkmcnt(0)
  v_mfma_f32_32x32x16_bf16 v[128:143], a[172:175], v[28:31], v[128:143]
  s_barrier
  s_waitcnt vmcnt(22)
  v_mfma_f32_32x32x16_bf16 v[112:127], a[176:179], v[32:35], v[112:127]
  buffer_load_dwordx4 v[28:31], v4, s[28:31], s49 offen offset:3072 sc1
  ds_read_b128 v[192:195], v15 offset:0
  ds_read_b128 v[196:199], v15 offset:1024
  v_mfma_f32_32x32x16_bf16 v[128:143], a[180:183], v[32:35], v[128:143]
  ds_read_b128 v[200:203], v15 offset:2048
  ds_read_b128 v[204:207], v15 offset:3072
  s_waitcnt vmcnt(22)
  v_mfma_f32_32x32x16_bf16 v[112:127], a[184:187], v[36:39], v[112:127]
  s_add_u32 s49, s49, 4096
  buffer_load_dwordx4 v[32:35], v4, s[28:31], s49 offen offset:0 sc1
  ds_read_b128 v[208:211], v15 offset:4096
  ds_read_b128 v[212:215], v15 offset:5120
  v_mfma_f32_32x32x16_bf16 v[128:143], a[188:191], v[36:39], v[128:143]
  ds_read_b128 v[216:219], v15 offset:6144
  ds_read_b128 v[220:223], v15 offset:7168
  s_waitcnt vmcnt(20)
  v_mfma_f32_32x32x16_bf16 v[112:127], a[192:195], v[40:43], v[112:127]
  buffer_load_dwordx4 v[36:39], v4, s[28:31], s49 offen offset:1024 sc1
  ds_read_b64_tr_b16 v[224:225], v7 offset:0
  ds_read_b64_tr_b16 v[226:227], v7 offset:512
  v_mfma_f32_32x32x16_bf16 v[128:143], a[196:199], v[40:43], v[128:143]
  ds_read_b64_tr_b16 v[228:229], v7 offset:1024
  ds_read_b64_tr_b16 v[230:231], v7 offset:1536
  s_waitcnt vmcnt(20)
  v_mfma_f32_32x32x16_bf16 v[112:127], a[200:203], v[44:47], v[112:127]
  buffer_load_dwordx4 v[40:43], v4, s[28:31], s49 offen offset:2048 sc1
  s_waitcnt vmcnt(13)
  v_add_f32 v8, v160, v162
  v_add_f32 v11, v161, v163
  v_add_f32 v10, v164, v166
  v_mfma_f32_32x32x16_bf16 v[128:143], a[204:207], v[44:47], v[128:143]
  v_add_f32 v13, v165, v167
  v_add_f32 v8, v8, v168
  v_add_f32 v11, v11, v169
  v_add_f32 v10, v10, v170
  s_waitcnt vmcnt(18)
  v_mfma_f32_32x32x16_bf16 v[112:127], a[208:211], v[48:51], v[112:127]
  buffer_load_dwordx4 v[44:47], v4, s[28:31], s49 offen offset:3072 sc1
  v_add_f32 v13, v13, v171
  v_add_f32 v8, v8, v172
  v_add_f32 v11, v11, v173
  v_add_f32 v10, v10, v174
  v_mfma_f32_32x32x16_bf16 v[128:143], a[212:215], v[48:51], v[128:143]
  v_add_f32 v13, v13, v175
  v_add_f32 v8, v8, v176
  v_add_f32 v11, v11, v177
  s_waitcnt vmcnt(16)
  v_mfma_f32_32x32x16_bf16 v[112:127], a[216:219], v[52:55], v[112:127]
  v_add_f32 v10, v10, v178
  v_add_f32 v13, v13, v179
  v_add_f32 v8, v8, v180
  v_add_f32 v11, v11, v181
  v_mfma_f32_32x32x16_bf16 v[128:143], a[220:223], v[52:55], v[128:143]
  v_add_f32 v10, v10, v182
  v_add_f32 v13, v13, v183
  v_add_f32 v8, v8, v184
  s_waitcnt vmcnt(13)
  v_mfma_f32_32x32x16_bf16 v[112:127], a[224:227], v[56:59], v[112:127]
  v_add_f32 v11, v11, v185
  v_add_f32 v10, v10, v186
  v_add_f32 v13, v13, v187
  v_add_f32 v8, v8, v10
  v_mfma_f32_32x32x16_bf16 v[128:143], a[228:231], v[56:59], v[128:143]
  v_add_f32 v11, v11, v13
  s_mov_b32 s53, 0x3b124925
  v_mul_f32 v8, s53, v8
  s_waitcnt vmcnt(12)
  v_mfma_f32_32x32x16_bf16 v[112:127], a[232:235], v[60:63], v[112:127]
  v_mul_f32 v10, v8, v8
  v_fma_f32 v11, v11, s53, -v10
  v_max_f32 v11, 0, v11
  v_cvt_pk_bf16_f32 v11, v11, v11
  v_mfma_f32_32x32x16_bf16 v[128:143], a[236:239], v[60:63], v[128:143]
  v_lshlrev_b32 v11, 16, v11
  v_add_f32 v11, 0x3727c5ac, v11
  v_cvt_pk_bf16_f32 v11, v11, v11
  s_waitcnt vmcnt(11)
  v_mfma_f32_32x32x16_bf16 v[112:127], a[240:243], v[64:67], v[112:127]
  v_lshlrev_b32 v11, 16, v11
  v_sqrt_f32 v10, v11
  s_nop 0
  v_cvt_pk_bf16_f32 v10, v10, v10
  v_mfma_f32_32x32x16_bf16 v[128:143], a[244:247], v[64:67], v[128:143]
  v_lshlrev_b32 v10, 16, v10
  v_rcp_f32 v12, v10
  v_cvt_pk_bf16_f32 v8, v8, v8
  s_waitcnt vmcnt(10)
  v_mfma_f32_32x32x16_bf16 v[112:127], a[248:251], v[68:71], v[112:127]
  v_lshlrev_b32 v8, 16, v8
  v_mul_f32 v250, v8, v12
  v_sub_f32 v250, 0, v250
  v_mfma_f32_32x32x16_bf16 v[128:143], a[252:255], v[68:71], v[128:143]
  v_mov_b32 v13, v12
  s_nop 1
  v_permlane32_swap_b32 v12, v13
  s_waitcnt vmcnt(9)
  v_mfma_f32_32x32x16_bf16 v[112:127], a[0:3], v[72:75], v[112:127]
  v_mfma_f32_32x32x16_bf16 v[128:143], a[4:7], v[72:75], v[128:143]
  s_waitcnt vmcnt(8)
  v_mfma_f32_32x32x16_bf16 v[112:127], a[8:11], v[76:79], v[112:127]
  s_waitcnt lgkmcnt(0)
  v_add_f32 v192, v192, v200
  v_add_f32 v193, v193, v201
  v_add_f32 v194, v194, v202
  v_mfma_f32_32x32x16_bf16 v[128:143], a[12:15], v[76:79], v[128:143]
  v_add_f32 v195, v195, v203
  v_add_f32 v196, v196, v204
  v_add_f32 v197, v197, v205
  s_waitcnt vmcnt(7)
  v_mfma_f32_32x32x16_bf16 v[112:127], a[16:19], v[16:19], v[112:127]
  v_add_f32 v198, v198, v206
  v_add_f32 v199, v199, v207
  v_add_f32 v208, v208, v216
  v_mfma_f32_32x32x16_bf16 v[128:143], a[20:23], v[16:19], v[128:143]
  v_add_f32 v209, v209, v217
  v_add_f32 v210, v210, v218
  v_add_f32 v211, v211, v219
  s_waitcnt vmcnt(6)
  v_mfma_f32_32x32x16_bf16 v[112:127], a[24:27], v[20:23], v[112:127]
  v_add_f32 v212, v212, v220
  v_add_f32 v213, v213, v221
  v_add_f32 v214, v214, v222
  v_mfma_f32_32x32x16_bf16 v[128:143], a[28:31], v[20:23], v[128:143]
  v_add_f32 v215, v215, v223
  v_lshlrev_b32 v232, 16, v224
  v_and_b32 v233, 0xffff0000, v224
  s_waitcnt vmcnt(5)
  v_mfma_f32_32x32x16_bf16 v[112:127], a[32:35], v[24:27], v[112:127]
  v_lshlrev_b32 v234, 16, v225
  v_and_b32 v235, 0xffff0000, v225
  v_lshlrev_b32 v236, 16, v226
  v_mfma_f32_32x32x16_bf16 v[128:143], a[36:39], v[24:27], v[128:143]
  v_and_b32 v237, 0xffff0000, v226
  v_lshlrev_b32 v238, 16, v227
  v_and_b32 v239, 0xffff0000, v227
  s_waitcnt vmcnt(4)
  v_mfma_f32_32x32x16_bf16 v[112:127], a[40:43], v[28:31], v[112:127]
  v_add_f32 v192, v192, v208
  v_add_f32 v193, v193, v209
  v_add_f32 v194, v194, v210
  v_mfma_f32_32x32x16_bf16 v[128:143], a[44:47], v[28:31], v[128:143]
  v_add_f32 v195, v195, v211
  v_add_f32 v196, v196, v212
  v_add_f32 v197, v197, v213
  s_waitcnt vmcnt(3)
  v_mfma_f32_32x32x16_bf16 v[112:127], a[48:51], v[32:35], v[112:127]
  v_add_f32 v198, v198, v214
  v_add_f32 v199, v199, v215
  v_fma_f32 v232, v192, v12, v232
  v_mfma_f32_32x32x16_bf16 v[128:143], a[52:55], v[32:35], v[128:143]
  v_fma_f32 v233, v193, v12, v233
  v_fma_f32 v234, v194, v12, v234
  v_fma_f32 v235, v195, v12, v235
  s_waitcnt vmcnt(2)
  v_mfma_f32_32x32x16_bf16 v[112:127], a[56:59], v[36:39], v[112:127]
  v_fma_f32 v236, v196, v12, v236
  v_fma_f32 v237, v197, v12, v237
  v_fma_f32 v238, v198, v12, v238
  v_mfma_f32_32x32x16_bf16 v[128:143], a[60:63], v[36:39], v[128:143]
  v_fma_f32 v239, v199, v12, v239
  v_cvt_pk_bf16_f32 v244, v232, v233
  v_cvt_pk_bf16_f32 v245, v234, v235
  s_waitcnt vmcnt(1)
  v_mfma_f32_32x32x16_bf16 v[112:127], a[64:67], v[40:43], v[112:127]
  v_cvt_pk_bf16_f32 v246, v236, v237
  v_cvt_pk_bf16_f32 v247, v238, v239
  s_nop 1
  v_mfma_f32_32x32x16_bf16 v[128:143], a[68:71], v[40:43], v[128:143]
  v_permlane32_swap_b32 v244, v246
  v_permlane32_swap_b32 v245, v247
  buffer_store_dwordx4 v[244:247], v9, s[16:19], s48 offen
  s_waitcnt vmcnt(1)
  v_mfma_f32_32x32x16_bf16 v[112:127], a[72:75], v[44:47], v[112:127]
  v_mfma_f32_32x32x16_bf16 v[128:143], a[76:79], v[44:47], v[128:143]
  s_nop 9
  v_add_u32 v14, 75264, v14
  v_add_u32 v15, 75264, v15
  ds_write_b128 v14, v[112:115] offset:0
  ds_write_b128 v14, v[116:119] offset:1024
  ds_write_b128 v14, v[128:131] offset:8192
  ds_write_b128 v14, v[132:135] offset:9216
  ds_write_b128 v14, v[120:123] offset:16384
  ds_write_b128 v14, v[124:127] offset:17408
  ds_write_b128 v14, v[136:139] offset:24576
  ds_write_b128 v14, v[140:143] offset:25600
  s_waitcnt lgkmcnt(0)
  s_barrier
  ds_read_b128 v[192:195], v15 offset:0
  ds_read_b128 v[196:199], v15 offset:1024
  ds_read_b128 v[200:203], v15 offset:2048
  ds_read_b128 v[204:207], v15 offset:3072
  ds_read_b128 v[208:211], v15 offset:4096
  ds_read_b128 v[212:215], v15 offset:5120
  ds_read_b128 v[216:219], v15 offset:6144
  ds_read_b128 v[220:223], v15 offset:7168
  s_add_u32 s48, s48, 917504
  s_waitcnt lgkmcnt(0)
  v_add_f32 v192, v192, v200
  v_add_f32 v193, v193, v201
  v_add_f32 v194, v194, v202
  v_add_f32 v195, v195, v203
  v_add_f32 v196, v196, v204
  v_add_f32 v197, v197, v205
  v_add_f32 v198, v198, v206
  v_add_f32 v199, v199, v207
  v_add_f32 v208, v208, v216
  v_add_f32 v209, v209, v217
  v_add_f32 v210, v210, v218
  v_add_f32 v211, v211, v219
  v_add_f32 v212, v212, v220
  v_add_f32 v213, v213, v221
  v_add_f32 v214, v214, v222
  v_add_f32 v215, v215, v223
  v_lshlrev_b32 v232, 16, v228
  v_and_b32 v233, 0xffff0000, v228
  v_lshlrev_b32 v234, 16, v229
  v_and_b32 v235, 0xffff0000, v229
  v_lshlrev_b32 v236, 16, v230
  v_and_b32 v237, 0xffff0000, v230
  v_lshlrev_b32 v238, 16, v231
  v_and_b32 v239, 0xffff0000, v231
  v_add_f32 v192, v192, v208
  v_add_f32 v193, v193, v209
  v_add_f32 v194, v194, v210
  v_add_f32 v195, v195, v211
  v_add_f32 v196, v196, v212
  v_add_f32 v197, v197, v213
  v_add_f32 v198, v198, v214
  v_add_f32 v199, v199, v215
  v_fma_f32 v232, v192, v13, v232
  v_fma_f32 v233, v193, v13, v233
  v_fma_f32 v234, v194, v13, v234
  v_fma_f32 v235, v195, v13, v235
  v_fma_f32 v236, v196, v13, v236
  v_fma_f32 v237, v197, v13, v237
  v_fma_f32 v238, v198, v13, v238
  v_fma_f32 v239, v199, v13, v239
  v_cvt_pk_bf16_f32 v16, v232, v233
  v_cvt_pk_bf16_f32 v17, v234, v235
  v_cvt_pk_bf16_f32 v18, v236, v237
  v_cvt_pk_bf16_f32 v19, v238, v239
  s_nop 1
  v_permlane32_swap_b32 v16, v18
  v_permlane32_swap_b32 v17, v19
  buffer_store_dwordx4 v[16:19], v9, s[16:19], s48 offen
  s_endpgm
KA_aux:
  s_cmp_ge_u32 s2, 252
  s_cbranch_scc1 KA_zero
  s_sub_u32 s41, s2, 224
  v_lshrrev_b32 v3, 3, v2
  v_mul_u32_u24 v3, 3584, v3
  v_and_b32 v5, 7, v2
  v_lshl_add_u32 v3, v5, 4, v3
  s_lshl_b32 s42, s41, 7
  s_mul_i32 s43, s40, 401408
  s_add_u32 s42, s42, s43
  s_mul_i32 s44, s40, 14336
  s_waitcnt lgkmcnt(0)
  s_mov_b32 s28, s24
  s_mov_b32 s29, s25
  s_mov_b32 s30, 20971520
  s_mov_b32 s31, 0x20000
  s_mov_b32 s32, s16
  s_mov_b32 s33, s17
  s_mov_b32 s34, 1605632
  s_mov_b32 s35, 0x20000
  s_add_u32 m0, s44, 0
  s_add_u32 s45, s42, 0
  buffer_load_dwordx4 v3, s[32:35], s45 offen nt lds
  s_add_u32 m0, s44, 1024
  s_add_u32 s45, s42, 28672
  buffer_load_dwordx4 v3, s[32:35], s45 offen nt lds
  s_add_u32 m0, s44, 2048
  s_add_u32 s45, s42, 57344
  buffer_load_dwordx4 v3, s[32:35], s45 offen nt lds
  s_add_u32 m0, s44, 3072
  s_add_u32 s45, s42, 86016
  buffer_load_dwordx4 v3, s[32:35], s45 offen nt lds
  s_add_u32 m0, s44, 4096
  s_add_u32 s45, s42, 114688
  buffer_load_dwordx4 v3, s[32:35], s45 offen nt lds
  s_add_u32 m0, s44, 5120
  s_add_u32 s45, s42, 143360
  buffer_load_dwordx4 v3, s[32:35], s45 offen nt lds
  s_add_u32 m0, s44, 6144
  s_add_u32 s45, s42, 172032
  buffer_load_dwordx4 v3, s[32:35], s45 offen nt lds
  s_add_u32 m0, s44, 7168
  s_add_u32 s45, s42, 200704
  buffer_load_dwordx4 v3, s[32:35], s45 offen nt lds
  s_add_u32 m0, s44, 8192
  s_add_u32 s45, s42, 229376
  buffer_load_dwordx4 v3, s[32:35], s45 offen nt lds
  s_add_u32 m0, s44, 9216
  s_add_u32 s45, s42, 258048
  buffer_load_dwordx4 v3, s[32:35], s45 offen nt lds
  s_add_u32 m0, s44, 10240
  s_add_u32 s45, s42, 286720
  buffer_load_dwordx4 v3, s[32:35], s45 offen nt lds
  s_add_u32 m0, s44, 11264
  s_add_u32 s45, s42, 315392
  buffer_load_dwordx4 v3, s[32:35], s45 offen nt lds
  s_add_u32 m0, s44, 12288
  s_add_u32 s45, s42, 344064
  buffer_load_dwordx4 v3, s[32:35], s45 offen nt lds
  s_add_u32 m0, s44, 13312
  s_add_u32 s45, s42, 372736
  buffer_load_dwordx4 v3, s[32:35], s45 offen nt lds
  v_lshrrev_b32 v5, 5, v2
  v_bfe_u32 v6, v2, 2, 2
  v_lshl_add_u32 v6, v5, 3, v6
  v_lshlrev_b32 v6, 7, v6
  v_bfe_u32 v7, v2, 4, 1
  v_lshl_add_u32 v6, v7, 5, v6
  v_and_b32 v7, 3, v2
  v_lshl_add_u32 v6, v7, 3, v6
  v_add_u32 v6, s44, v6
  v_lshlrev_b32 v9, 2, v2
  s_lshl_b32 s45, s40, 8
  v_add_u32 v10, s45, v9
  v_and_b32 v11, 31, v2
  v_lshlrev_b32 v11, 2, v11
  s_mov_b32 s50, 0x3f803f80
  v_mov_b32 v12, 0
  v_mov_b32 v13, 0
  v_mov_b32 v14, 0
  v_mov_b32 v15, 0
  s_waitcnt vmcnt(12)
  ds_read_b64_tr_b16 v[16:17], v6 offset:0
  ds_read_b64_tr_b16 v[18:19], v6 offset:512
  ds_read_b64_tr_b16 v[44:45], v6 offset:64
  ds_read_b64_tr_b16 v[46:47], v6 offset:576
  s_waitcnt vmcnt(10)
  ds_read_b64_tr_b16 v[20:21], v6 offset:2048
  ds_read_b64_tr_b16 v[22:23], v6 offset:2560
  ds_read_b64_tr_b16 v[48:49], v6 offset:2112
  ds_read_b64_tr_b16 v[50:51], v6 offset:2624
  s_waitcnt lgkmcnt(4)
  v_dot2_f32_bf16 v12, v16, s50, v12
  v_dot2_f32_bf16 v14, v17, s50, v14
  v_dot2_f32_bf16 v12, v18, s50, v12
  v_dot2_f32_bf16 v14, v19, s50, v14
  v_dot2_f32_bf16 v13, v44, s50, v13
  v_dot2_f32_bf16 v15, v45, s50, v15
  v_dot2_f32_bf16 v13, v46, s50, v13
  v_dot2_f32_bf16 v15, v47, s50, v15
  s_waitcnt vmcnt(8)
  ds_read_b64_tr_b16 v[24:25], v6 offset:4096
  ds_read_b64_tr_b16 v[26:27], v6 offset:4608
  ds_read_b64_tr_b16 v[52:53], v6 offset:4160
  ds_read_b64_tr_b16 v[54:55], v6 offset:4672
  s_waitcnt lgkmcnt(4)
  v_dot2_f32_bf16 v12, v20, s50, v12
  v_dot2_f32_bf16 v14, v21, s50, v14
  v_dot2_f32_bf16 v12, v22, s50, v12
  v_dot2_f32_bf16 v14, v23, s50, v14
  v_dot2_f32_bf16 v13, v48, s50, v13
  v_dot2_f32_bf16 v15, v49, s50, v15
  v_dot2_f32_bf16 v13, v50, s50, v13
  v_dot2_f32_bf16 v15, v51, s50, v15
  s_waitcnt vmcnt(6)
  ds_read_b64_tr_b16 v[28:29], v6 offset:6144
  ds_read_b64_tr_b16 v[30:31], v6 offset:6656
  ds_read_b64_tr_b16 v[56:57], v6 offset:6208
  ds_read_b64_tr_b16 v[58:59], v6 offset:6720
  s_waitcnt lgkmcnt(4)
  v_dot2_f32_bf16 v12, v24, s50, v12
  v_dot2_f32_bf16 v14, v25, s50, v14
  v_dot2_f32_bf16 v12, v26, s50, v12
  v_dot2_f32_bf16 v14, v27, s50, v14
  v_dot2_f32_bf16 v13, v52, s50, v13
  v_dot2_f32_bf16 v15, v53, s50, v15
  v_dot2_f32_bf16 v13, v54, s50, v13
  v_dot2_f32_bf16 v15, v55, s50, v15
  s_waitcnt vmcnt(4)
  ds_read_b64_tr_b16 v[32:33], v6 offset:8192
  ds_read_b64_tr_b16 v[34:35], v6 offset:8704
  ds_read_b64_tr_b16 v[60:61], v6 offset:8256
  ds_read_b64_tr_b16 v[62:63], v6 offset:8768
  s_waitcnt lgkmcnt(4)
  v_dot2_f32_bf16 v12, v28, s50, v12
  v_dot2_f32_bf16 v14, v29, s50, v14
  v_dot2_f32_bf16 v12, v30, s50, v12
  v_dot2_f32_bf16 v14, v31, s50, v14
  v_dot2_f32_bf16 v13, v56, s50, v13
  v_dot2_f32_bf16 v15, v57, s50, v15
  v_dot2_f32_bf16 v13, v58, s50, v13
  v_dot2_f32_bf16 v15, v59, s50, v15
  s_waitcnt vmcnt(2)
  ds_read_b64_tr_b16 v[36:37], v6 offset:10240
  ds_read_b64_tr_b16 v[38:39], v6 offset:10752
  ds_read_b64_tr_b16 v[64:65], v6 offset:10304
  ds_read_b64_tr_b16 v[66:67], v6 offset:10816
  s_waitcnt lgkmcnt(4)
  v_dot2_f32_bf16 v12, v32, s50, v12
  v_dot2_f32_bf16 v14, v33, s50, v14
  v_dot2_f32_bf16 v12, v34, s50, v12
  v_dot2_f32_bf16 v14, v35, s50, v14
  v_dot2_f32_bf16 v13, v60, s50, v13
  v_dot2_f32_bf16 v15, v61, s50, v15
  v_dot2_f32_bf16 v13, v62, s50, v13
  v_dot2_f32_bf16 v15, v63, s50, v15
  s_waitcnt vmcnt(0)
  ds_read_b64_tr_b16 v[40:41], v6 offset:12288
  ds_read_b64_tr_b16 v[42:43], v6 offset:12800
  ds_read_b64_tr_b16 v[68:69], v6 offset:12352
  ds_read_b64_tr_b16 v[70:71], v6 offset:12864
  s_waitcnt lgkmcnt(4)
  v_dot2_f32_bf16 v12, v36, s50, v12
  v_dot2_f32_bf16 v14, v37, s50, v14
  v_dot2_f32_bf16 v12, v38, s50, v12
  v_dot2_f32_bf16 v14, v39, s50, v14
  v_dot2_f32_bf16 v13, v64, s50, v13
  v_dot2_f32_bf16 v15, v65, s50, v15
  v_dot2_f32_bf16 v13, v66, s50, v13
  v_dot2_f32_bf16 v15, v67, s50, v15
  s_waitcnt lgkmcnt(0)
  v_dot2_f32_bf16 v12, v40, s50, v12
  v_dot2_f32_bf16 v14, v41, s50, v14
  v_dot2_f32_bf16 v12, v42, s50, v12
  v_dot2_f32_bf16 v14, v43, s50, v14
  v_dot2_f32_bf16 v13, v68, s50, v13
  v_dot2_f32_bf16 v15, v69, s50, v15
  v_dot2_f32_bf16 v13, v70, s50, v13
  v_dot2_f32_bf16 v15, v71, s50, v15
  s_cmp_lg_u32 s40, 0
  s_cbranch_scc1 KA_aw1
  v_mov_b32 v90, v10
  v_mov_b32 v91, v11
  v_mov_b32 v10, 0
  s_mov_b32 s63, 65536
KA_z1_l:
  global_load_dword v11, v10, s[22:23] sc1
  s_waitcnt vmcnt(0)
  v_readfirstlane_b32 s62, v11
  s_nop 3
  s_cmp_eq_u32 s62, 1
  s_cbranch_scc1 KA_z1_g
  s_sleep 2
  s_sub_u32 s63, s63, 1
  s_cmp_lg_u32 s63, 0
  s_cbranch_scc1 KA_z1_l
KA_z1_g:
  v_mov_b32 v10, v90
  v_mov_b32 v11, v91
KA_aw1:
  s_nop 2
  v_add_f32 v12, v12, v14
  v_add_f32 v13, v13, v15
  ds_write_b32 v10, v12 offset:57344
  ds_write_b32 v10, v13 offset:58368
  s_waitcnt lgkmcnt(0)
  s_barrier
  ds_read_b32 v72, v11 offset:57344
  ds_read_b32 v73, v11 offset:57472
  ds_read_b32 v74, v11 offset:57600
  ds_read_b32 v75, v11 offset:57728
  ds_read_b32 v76, v11 offset:57856
  ds_read_b32 v77, v11 offset:57984
  ds_read_b32 v78, v11 offset:58112
  ds_read_b32 v79, v11 offset:58240
  ds_read_b32 v80, v11 offset:58368
  ds_read_b32 v81, v11 offset:58496
  ds_read_b32 v82, v11 offset:58624
  ds_read_b32 v83, v11 offset:58752
  ds_read_b32 v84, v11 offset:58880
  ds_read_b32 v85, v11 offset:59008
  ds_read_b32 v86, v11 offset:59136
  ds_read_b32 v87, v11 offset:59264
  s_waitcnt lgkmcnt(8)
  v_add_f32 v72, v72, v76
  v_add_f32 v73, v73, v77
  v_add_f32 v74, v74, v78
  v_add_f32 v75, v75, v79
  v_add_f32 v72, v72, v74
  v_add_f32 v73, v73, v75
  v_add_f32 v72, v72, v73
  v_mul_f32 v72, 0xbb124925, v72
  v_mov_b32 v73, v72
  s_waitcnt lgkmcnt(0)
  v_add_f32 v80, v80, v84
  v_add_f32 v81, v81, v85
  v_add_f32 v82, v82, v86
  v_add_f32 v83, v83, v87
  v_add_f32 v80, v80, v82
  v_add_f32 v81, v81, v83
  v_add_f32 v80, v80, v81
  v_mul_f32 v80, 0xbb124925, v80
  v_mov_b32 v81, v80
  s_mul_i32 s46, s41, 57344
  s_mul_i32 s47, s40, 7168
  s_add_u32 s46, s46, s47
  s_add_u32 s46, s46, 7340032
  v_lshlrev_b32 v88, 16, v16
  v_and_b32 v89, 0xffff0000, v16
  v_lshlrev_b32 v90, 16, v17
  v_and_b32 v91, 0xffff0000, v17
  v_lshlrev_b32 v92, 16, v18
  v_and_b32 v93, 0xffff0000, v18
  v_lshlrev_b32 v94, 16, v19
  v_and_b32 v95, 0xffff0000, v19
  v_pk_add_f32 v[88:89], v[88:89], v[72:73]
  v_pk_add_f32 v[90:91], v[90:91], v[72:73]
  v_pk_add_f32 v[92:93], v[92:93], v[72:73]
  v_pk_add_f32 v[94:95], v[94:95], v[72:73]
  v_cvt_pk_bf16_f32 v16, v88, v89
  v_cvt_pk_bf16_f32 v17, v90, v91
  v_cvt_pk_bf16_f32 v18, v92, v93
  v_cvt_pk_bf16_f32 v19, v94, v95
  s_add_u32 s47, s46, 0
  buffer_store_dwordx4 v[16:19], v4, s[28:31], s47 offen offset:0 sc1
  v_lshlrev_b32 v88, 16, v20
  v_and_b32 v89, 0xffff0000, v20
  v_lshlrev_b32 v90, 16, v21
  v_and_b32 v91, 0xffff0000, v21
  v_lshlrev_b32 v92, 16, v22
  v_and_b32 v93, 0xffff0000, v22
  v_lshlrev_b32 v94, 16, v23
  v_and_b32 v95, 0xffff0000, v23
  v_pk_add_f32 v[88:89], v[88:89], v[72:73]
  v_pk_add_f32 v[90:91], v[90:91], v[72:73]
  v_pk_add_f32 v[92:93], v[92:93], v[72:73]
  v_pk_add_f32 v[94:95], v[94:95], v[72:73]
  v_cvt_pk_bf16_f32 v20, v88, v89
  v_cvt_pk_bf16_f32 v21, v90, v91
  v_cvt_pk_bf16_f32 v22, v92, v93
  v_cvt_pk_bf16_f32 v23, v94, v95
  buffer_store_dwordx4 v[20:23], v4, s[28:31], s47 offen offset:1024 sc1
  v_lshlrev_b32 v88, 16, v24
  v_and_b32 v89, 0xffff0000, v24
  v_lshlrev_b32 v90, 16, v25
  v_and_b32 v91, 0xffff0000, v25
  v_lshlrev_b32 v92, 16, v26
  v_and_b32 v93, 0xffff0000, v26
  v_lshlrev_b32 v94, 16, v27
  v_and_b32 v95, 0xffff0000, v27
  v_pk_add_f32 v[88:89], v[88:89], v[72:73]
  v_pk_add_f32 v[90:91], v[90:91], v[72:73]
  v_pk_add_f32 v[92:93], v[92:93], v[72:73]
  v_pk_add_f32 v[94:95], v[94:95], v[72:73]
  v_cvt_pk_bf16_f32 v24, v88, v89
  v_cvt_pk_bf16_f32 v25, v90, v91
  v_cvt_pk_bf16_f32 v26, v92, v93
  v_cvt_pk_bf16_f32 v27, v94, v95
  buffer_store_dwordx4 v[24:27], v4, s[28:31], s47 offen offset:2048 sc1
  v_lshlrev_b32 v88, 16, v28
  v_and_b32 v89, 0xffff0000, v28
  v_lshlrev_b32 v90, 16, v29
  v_and_b32 v91, 0xffff0000, v29
  v_lshlrev_b32 v92, 16, v30
  v_and_b32 v93, 0xffff0000, v30
  v_lshlrev_b32 v94, 16, v31
  v_and_b32 v95, 0xffff0000, v31
  v_pk_add_f32 v[88:89], v[88:89], v[72:73]
  v_pk_add_f32 v[90:91], v[90:91], v[72:73]
  v_pk_add_f32 v[92:93], v[92:93], v[72:73]
  v_pk_add_f32 v[94:95], v[94:95], v[72:73]
  v_cvt_pk_bf16_f32 v28, v88, v89
  v_cvt_pk_bf16_f32 v29, v90, v91
  v_cvt_pk_bf16_f32 v30, v92, v93
  v_cvt_pk_bf16_f32 v31, v94, v95
  buffer_store_dwordx4 v[28:31], v4, s[28:31], s47 offen offset:3072 sc1
  v_lshlrev_b32 v88, 16, v32
  v_and_b32 v89, 0xffff0000, v32
  v_lshlrev_b32 v90, 16, v33
  v_and_b32 v91, 0xffff0000, v33
  v_lshlrev_b32 v92, 16, v34
  v_and_b32 v93, 0xffff0000, v34
  v_lshlrev_b32 v94, 16, v35
  v_and_b32 v95, 0xffff0000, v35
  v_pk_add_f32 v[88:89], v[88:89], v[72:73]
  v_pk_add_f32 v[90:91], v[90:91], v[72:73]
  v_pk_add_f32 v[92:93], v[92:93], v[72:73]
  v_pk_add_f32 v[94:95], v[94:95], v[72:73]
  v_cvt_pk_bf16_f32 v32, v88, v89
  v_cvt_pk_bf16_f32 v33, v90, v91
  v_cvt_pk_bf16_f32 v34, v92, v93
  v_cvt_pk_bf16_f32 v35, v94, v95
  s_add_u32 s47, s46, 4096
  buffer_store_dwordx4 v[32:35], v4, s[28:31], s47 offen offset:0 sc1
  v_lshlrev_b32 v88, 16, v36
  v_and_b32 v89, 0xffff0000, v36
  v_lshlrev_b32 v90, 16, v37
  v_and_b32 v91, 0xffff0000, v37
  v_lshlrev_b32 v92, 16, v38
  v_and_b32 v93, 0xffff0000, v38
  v_lshlrev_b32 v94, 16, v39
  v_and_b32 v95, 0xffff0000, v39
  v_pk_add_f32 v[88:89], v[88:89], v[72:73]
  v_pk_add_f32 v[90:91], v[90:91], v[72:73]
  v_pk_add_f32 v[92:93], v[92:93], v[72:73]
  v_pk_add_f32 v[94:95], v[94:95], v[72:73]
  v_cvt_pk_bf16_f32 v36, v88, v89
  v_cvt_pk_bf16_f32 v37, v90, v91
  v_cvt_pk_bf16_f32 v38, v92, v93
  v_cvt_pk_bf16_f32 v39, v94, v95
  buffer_store_dwordx4 v[36:39], v4, s[28:31], s47 offen offset:1024 sc1
  v_lshlrev_b32 v88, 16, v40
  v_and_b32 v89, 0xffff0000, v40
  v_lshlrev_b32 v90, 16, v41
  v_and_b32 v91, 0xffff0000, v41
  v_lshlrev_b32 v92, 16, v42
  v_and_b32 v93, 0xffff0000, v42
  v_lshlrev_b32 v94, 16, v43
  v_and_b32 v95, 0xffff0000, v43
  v_pk_add_f32 v[88:89], v[88:89], v[72:73]
  v_pk_add_f32 v[90:91], v[90:91], v[72:73]
  v_pk_add_f32 v[92:93], v[92:93], v[72:73]
  v_pk_add_f32 v[94:95], v[94:95], v[72:73]
  v_cvt_pk_bf16_f32 v40, v88, v89
  v_cvt_pk_bf16_f32 v41, v90, v91
  v_cvt_pk_bf16_f32 v42, v92, v93
  v_cvt_pk_bf16_f32 v43, v94, v95
  buffer_store_dwordx4 v[40:43], v4, s[28:31], s47 offen offset:2048 sc1
  v_lshlrev_b32 v88, 16, v44
  v_and_b32 v89, 0xffff0000, v44
  v_lshlrev_b32 v90, 16, v45
  v_and_b32 v91, 0xffff0000, v45
  v_lshlrev_b32 v92, 16, v46
  v_and_b32 v93, 0xffff0000, v46
  v_lshlrev_b32 v94, 16, v47
  v_and_b32 v95, 0xffff0000, v47
  v_pk_add_f32 v[88:89], v[88:89], v[80:81]
  v_pk_add_f32 v[90:91], v[90:91], v[80:81]
  v_pk_add_f32 v[92:93], v[92:93], v[80:81]
  v_pk_add_f32 v[94:95], v[94:95], v[80:81]
  v_cvt_pk_bf16_f32 v44, v88, v89
  v_cvt_pk_bf16_f32 v45, v90, v91
  v_cvt_pk_bf16_f32 v46, v92, v93
  v_cvt_pk_bf16_f32 v47, v94, v95
  s_add_u32 s47, s46, 28672
  buffer_store_dwordx4 v[44:47], v4, s[28:31], s47 offen offset:0 sc1
  v_lshlrev_b32 v88, 16, v48
  v_and_b32 v89, 0xffff0000, v48
  v_lshlrev_b32 v90, 16, v49
  v_and_b32 v91, 0xffff0000, v49
  v_lshlrev_b32 v92, 16, v50
  v_and_b32 v93, 0xffff0000, v50
  v_lshlrev_b32 v94, 16, v51
  v_and_b32 v95, 0xffff0000, v51
  v_pk_add_f32 v[88:89], v[88:89], v[80:81]
  v_pk_add_f32 v[90:91], v[90:91], v[80:81]
  v_pk_add_f32 v[92:93], v[92:93], v[80:81]
  v_pk_add_f32 v[94:95], v[94:95], v[80:81]
  v_cvt_pk_bf16_f32 v48, v88, v89
  v_cvt_pk_bf16_f32 v49, v90, v91
  v_cvt_pk_bf16_f32 v50, v92, v93
  v_cvt_pk_bf16_f32 v51, v94, v95
  buffer_store_dwordx4 v[48:51], v4, s[28:31], s47 offen offset:1024 sc1
  v_lshlrev_b32 v88, 16, v52
  v_and_b32 v89, 0xffff0000, v52
  v_lshlrev_b32 v90, 16, v53
  v_and_b32 v91, 0xffff0000, v53
  v_lshlrev_b32 v92, 16, v54
  v_and_b32 v93, 0xffff0000, v54
  v_lshlrev_b32 v94, 16, v55
  v_and_b32 v95, 0xffff0000, v55
  v_pk_add_f32 v[88:89], v[88:89], v[80:81]
  v_pk_add_f32 v[90:91], v[90:91], v[80:81]
  v_pk_add_f32 v[92:93], v[92:93], v[80:81]
  v_pk_add_f32 v[94:95], v[94:95], v[80:81]
  v_cvt_pk_bf16_f32 v52, v88, v89
  v_cvt_pk_bf16_f32 v53, v90, v91
  v_cvt_pk_bf16_f32 v54, v92, v93
  v_cvt_pk_bf16_f32 v55, v94, v95
  buffer_store_dwordx4 v[52:55], v4, s[28:31], s47 offen offset:2048 sc1
  v_lshlrev_b32 v88, 16, v56
  v_and_b32 v89, 0xffff0000, v56
  v_lshlrev_b32 v90, 16, v57
  v_and_b32 v91, 0xffff0000, v57
  v_lshlrev_b32 v92, 16, v58
  v_and_b32 v93, 0xffff0000, v58
  v_lshlrev_b32 v94, 16, v59
  v_and_b32 v95, 0xffff0000, v59
  v_pk_add_f32 v[88:89], v[88:89], v[80:81]
  v_pk_add_f32 v[90:91], v[90:91], v[80:81]
  v_pk_add_f32 v[92:93], v[92:93], v[80:81]
  v_pk_add_f32 v[94:95], v[94:95], v[80:81]
  v_cvt_pk_bf16_f32 v56, v88, v89
  v_cvt_pk_bf16_f32 v57, v90, v91
  v_cvt_pk_bf16_f32 v58, v92, v93
  v_cvt_pk_bf16_f32 v59, v94, v95
  buffer_store_dwordx4 v[56:59], v4, s[28:31], s47 offen offset:3072 sc1
  v_lshlrev_b32 v88, 16, v60
  v_and_b32 v89, 0xffff0000, v60
  v_lshlrev_b32 v90, 16, v61
  v_and_b32 v91, 0xffff0000, v61
  v_lshlrev_b32 v92, 16, v62
  v_and_b32 v93, 0xffff0000, v62
  v_lshlrev_b32 v94, 16, v63
  v_and_b32 v95, 0xffff0000, v63
  v_pk_add_f32 v[88:89], v[88:89], v[80:81]
  v_pk_add_f32 v[90:91], v[90:91], v[80:81]
  v_pk_add_f32 v[92:93], v[92:93], v[80:81]
  v_pk_add_f32 v[94:95], v[94:95], v[80:81]
  v_cvt_pk_bf16_f32 v60, v88, v89
  v_cvt_pk_bf16_f32 v61, v90, v91
  v_cvt_pk_bf16_f32 v62, v92, v93
  v_cvt_pk_bf16_f32 v63, v94, v95
  s_add_u32 s47, s46, 32768
  buffer_store_dwordx4 v[60:63], v4, s[28:31], s47 offen offset:0 sc1
  v_lshlrev_b32 v88, 16, v64
  v_and_b32 v89, 0xffff0000, v64
  v_lshlrev_b32 v90, 16, v65
  v_and_b32 v91, 0xffff0000, v65
  v_lshlrev_b32 v92, 16, v66
  v_and_b32 v93, 0xffff0000, v66
  v_lshlrev_b32 v94, 16, v67
  v_and_b32 v95, 0xffff0000, v67
  v_pk_add_f32 v[88:89], v[88:89], v[80:81]
  v_pk_add_f32 v[90:91], v[90:91], v[80:81]
  v_pk_add_f32 v[92:93], v[92:93], v[80:81]
  v_pk_add_f32 v[94:95], v[94:95], v[80:81]
  v_cvt_pk_bf16_f32 v64, v88, v89
  v_cvt_pk_bf16_f32 v65, v90, v91
  v_cvt_pk_bf16_f32 v66, v92, v93
  v_cvt_pk_bf16_f32 v67, v94, v95
  buffer_store_dwordx4 v[64:67], v4, s[28:31], s47 offen offset:1024 sc1
  v_lshlrev_b32 v88, 16, v68
  v_and_b32 v89, 0xffff0000, v68
  v_lshlrev_b32 v90, 16, v69
  v_and_b32 v91, 0xffff0000, v69
  v_lshlrev_b32 v92, 16, v70
  v_and_b32 v93, 0xffff0000, v70
  v_lshlrev_b32 v94, 16, v71
  v_and_b32 v95, 0xffff0000, v71
  v_pk_add_f32 v[88:89], v[88:89], v[80:81]
  v_pk_add_f32 v[90:91], v[90:91], v[80:81]
  v_pk_add_f32 v[92:93], v[92:93], v[80:81]
  v_pk_add_f32 v[94:95], v[94:95], v[80:81]
  v_cvt_pk_bf16_f32 v68, v88, v89
  v_cvt_pk_bf16_f32 v69, v90, v91
  v_cvt_pk_bf16_f32 v70, v92, v93
  v_cvt_pk_bf16_f32 v71, v94, v95
  buffer_store_dwordx4 v[68:71], v4, s[28:31], s47 offen offset:2048 sc1
  s_waitcnt vmcnt(0)
  s_barrier
  s_cmp_lg_u32 s40, 0
  s_cbranch_scc1 KA_aw2
  s_and_b32 s62, s2, 3
  s_lshl_b32 s62, s62, 8
  s_add_u32 s62, s62, 20267008
  s_mov_b64 exec, 1
  v_mov_b32 v10, 0
  v_mov_b32 v11, 1
  buffer_atomic_add v11, v10, s[28:31], s62 offen sc1
  s_mov_b64 exec, -1
KA_aw2:
  s_endpgm
KA_zero:
  s_cmp_lg_u32 s2, 252
  s_cbranch_scc1 KA_done
  s_cmp_lg_u32 s40, 0
  s_cbranch_scc1 KA_done
  v_lshlrev_b32 v5, 8, v2
  v_mov_b32 v6, 0
  s_waitcnt lgkmcnt(0)
  s_mov_b32 s28, s24
  s_mov_b32 s29, s25
  s_mov_b32 s30, 20971520
  s_mov_b32 s31, 0x20000
  s_mov_b32 s43, 20185088
  buffer_store_dword v6, v5, s[28:31], s43 offen sc1
  s_mov_b32 s43, 20201472
  buffer_store_dword v6, v5, s[28:31], s43 offen sc1
  s_mov_b32 s43, 20217856
  buffer_store_dword v6, v5, s[28:31], s43 offen sc1
  s_mov_b32 s43, 20234240
  buffer_store_dword v6, v5, s[28:31], s43 offen sc1
  s_mov_b32 s43, 20250624
  buffer_store_dword v6, v5, s[28:31], s43 offen sc1
  s_mov_b32 s43, 20267008
  buffer_store_dword v6, v5, s[28:31], s43 offen sc1
  s_waitcnt vmcnt(0)
  s_mov_b64 exec, 1
  v_mov_b32 v7, 1
  global_store_dword v6, v7, s[22:23] sc1
KA_done:
  s_endpgm

.section .rodata,"a"
.p2align 6
.amdhsa_kernel sequential_preLN__ssm_conv_h3__dense_activation_relu__prompt_kernel
  .amdhsa_next_free_vgpr 512
  .amdhsa_next_free_sgpr 102
  .amdhsa_accum_offset 256
  .amdhsa_group_segment_fixed_size 0
  .amdhsa_kernarg_size 96
  .amdhsa_user_sgpr_count 2
  .amdhsa_user_sgpr_kernarg_segment_ptr 1
  .amdhsa_system_sgpr_workgroup_id_x 1
  .amdhsa_float_denorm_mode_32 3
.end_amdhsa_kernel
```
